```python
import torch

def _softmax(x, axis=-1):
    return torch.softmax(x, dim=axis)
def _gelu(x):
    return torch.nn.functional.gelu(x, approximate="tanh")
def _silu(x):
    return torch.nn.functional.silu(x)
def _sigmoid(x):
    return torch.sigmoid(x)
def _layernorm(x, axis=-1, eps=1e-5):
    m = x.mean(dim=axis, keepdim=True)
    v = x.var(dim=axis, keepdim=True, unbiased=False)
    return (x - m) / torch.sqrt(v + eps)
def _scatter_add(tgt, idx, src, axis=0):
    return tgt.clone().index_add_(axis, idx, src)
def _segment_sum(src, seg, n):
    out = torch.zeros((n,) + src.shape[1:], dtype=src.dtype)
    return out.index_add_(0, seg, src)
def _pad(x, pw):
    flat = tuple(v for pair in reversed(pw) for v in pair)
    return torch.nn.functional.pad(x, flat)

kernel_name = 'parallel_sum__grouped_kv_mqa__mixer_token_mlp__prompt'

def setup_inputs():

    _w = (lambda a: (lambda t: t.to(torch.bfloat16) if t.is_floating_point() else t)(torch.as_tensor(a)))
    def _A_setup():
        B, S, D, H = 1, 2048, 448, 16
        Dh = D // H
        return {
            "x": _w((lambda *s: torch.randn(*s, dtype=torch.bfloat16) * 0.05)(B, S, D)),
            "wq": _w((lambda *s: torch.randn(*s, dtype=torch.bfloat16) * 0.05)(D, H * Dh)),
            "wk": _w((lambda *s: torch.randn(*s, dtype=torch.bfloat16) * 0.05)(D, Dh)),
            "wv": _w((lambda *s: torch.randn(*s, dtype=torch.bfloat16) * 0.05)(D, Dh)),
            "wo": _w((lambda *s: torch.randn(*s, dtype=torch.bfloat16) * 0.05)(H * Dh, D)),
        }
    _A_in = _A_setup()

    def _B_setup():
        B, S, D, F = 1, 2048, 448, 1792
        return {
            "x": _w((lambda *s: torch.randn(*s, dtype=torch.bfloat16) * 0.05)(B, S, D)),
            "w1": _w((lambda *s: torch.randn(*s, dtype=torch.bfloat16) * 0.8)(S, F) * (S ** -0.5)),
            "b1": _w((lambda *s: torch.randn(*s, dtype=torch.bfloat16) * 12.8)(F) * 0.02),
            "w2": _w((lambda *s: torch.randn(*s, dtype=torch.bfloat16) * 0.2)(F, S) * (F ** -0.5)),
            "b2": _w((lambda *s: torch.randn(*s, dtype=torch.bfloat16) * 1.6)(S) * 0.02),
        }
    _B_in = _B_setup()

    return {
        "A_x": _A_in["x"],
        "A_wq": _A_in["wq"],
        "A_wk": _A_in["wk"],
        "A_wv": _A_in["wv"],
        "A_wo": _A_in["wo"],
        "B_x": _B_in["x"],
        "B_w1": _B_in["w1"],
        "B_b1": _B_in["b1"],
        "B_w2": _B_in["w2"],
        "B_b2": _B_in["b2"],
    }

def reference(A_x, A_wq, A_wk, A_wv, A_wo, B_x, B_w1, B_b1, B_w2, B_b2):
    def _A_ref(x, wq, wk, wv, wo):
        B, S, D = x.shape
        H = 16
        Dh = D // H
        q = (lambda x, *d: x.permute(*d))((x @ wq).reshape(B, S, H, Dh), 0, 2, 1, 3)
        k = x @ wk
        v = x @ wv
        scores = torch.einsum("bhqd,bkd->bhqk", q, k) * (Dh ** -0.5)
        p = _softmax(scores, axis=-1)
        o = torch.einsum("bhqk,bkd->bhqd", p, v)
        return (lambda x, *d: x.permute(*d))(o, 0, 2, 1, 3).reshape(B, S, H * Dh) @ wo

    def _B_ref(x, w1, b1, w2, b2):
        B, S, D = x.shape
        h = _layernorm(x, axis=-1)
        u = torch.einsum("bsd,sf->bdf", h, w1) + b1
        u = _gelu(u)
        y = torch.einsum("bdf,fs->bds", u, w2) + b2
        return (lambda x, *d: x.permute(*d))(y, 0, 2, 1)

    x = A_x
    xn = _layernorm(x, axis=-1)
    return x + _A_ref(xn, A_wq, A_wk, A_wv, A_wo) + _B_ref(xn, B_w1, B_b1, B_w2, B_b2)
```

```asm
; @launch grid=(256,1,1) block=(512,1,1) lds=159744
.amdgcn_target "amdgcn-amd-amdhsa--gfx950"
.text
.globl parallel_sum__grouped_kv_mqa__mixer_token_mlp__prompt_kernel
.p2align 8
.type parallel_sum__grouped_kv_mqa__mixer_token_mlp__prompt_kernel,@function
parallel_sum__grouped_kv_mqa__mixer_token_mlp__prompt_kernel:
    s_cmp_ge_u32 s2, 256
    s_cbranch_scc1 finx
    s_load_dwordx16 s[16:31], s[0:1], 0
    s_load_dwordx8 s[32:39], s[0:1], 64
    s_load_dwordx2 s[40:41], s[0:1], 96
    v_lshrrev_b32 v5, 6, v0
    v_and_b32 v1, 63, v0
    v_readfirstlane_b32 s7, v5
    v_and_b32 v2, 31, v0
    v_lshrrev_b32 v3, 5, v1
    v_lshlrev_b32 v4, 4, v1
    s_and_b32 s3, s2, 7
    s_lshr_b32 s4, s2, 3
    s_cmp_lg_u32 s7, 7
    s_cbranch_scc1 nocpf
    s_getpc_b64 s[72:73]
cpf_here:
    s_sub_u32 s72, s72, cpf_here-parallel_sum__grouped_kv_mqa__mixer_token_mlp__prompt_kernel
    s_subb_u32 s73, s73, 0
    s_mov_b32 s74, code_end-parallel_sum__grouped_kv_mqa__mixer_token_mlp__prompt_kernel
    s_mov_b32 s75, 0x20000
    s_lshl_b32 s8, s4, 7
    v_lshlrev_b32 v6, 12, v1
    buffer_load_dword v250, v6, s[72:75], s8 offen
nocpf:
    s_lshr_b32 s8, s4, 3
    s_lshl_b32 s5, s3, 2
    s_add_u32 s5, s5, s8
    s_and_b32 s6, s4, 7
    s_mov_b32 s14, 0
    s_mov_b32 s15, -1
    s_mov_b32 s82, 0x3f803f80
    v_lshlrev_b32 v5, 2, v1
    v_add_u32 v5, 159360, v5
    v_mov_b32 v6, 0
    ds_write_b32 v5, v6
    v_mov_b32 v0, 159360
    v_mov_b32 v29, 1
    v_lshrrev_b32 v5, 3, v1
    v_and_b32 v6, 7, v1
    v_lshrrev_b32 v7, 4, v1
    v_bfe_u32 v8, v1, 2, 2
    v_and_b32 v9, 3, v1
    v_and_b32 v10, 1, v7
    v_lshlrev_b32 v9, 3, v9
    v_lshl_add_u32 v9, v10, 5, v9
    v_mul_u32_u24 v20, 896, v5
    v_xor_b32 v21, v6, v7
    v_lshl_add_u32 v11, v21, 4, v20
    v_xor_b32 v21, 4, v21
    v_lshl_add_u32 v12, v21, 4, v20
    v_lshlrev_b32 v21, 2, v10
    v_xor_b32 v21, v21, v6
    v_lshl_add_u32 v13, v21, 4, v20
    s_and_b32 s80, s7, 3
    s_cmp_eq_u32 s80, 3
    s_cselect_b32 s76, 1, 2
    s_bfe_u32 s79, s6, 0x10001
    s_lshl_b32 s8, s5, 1
    s_add_u32 s8, s8, s79
    s_mul_i32 s77, s8, 28672
    s_lshl_b32 s8, s80, 8
    s_add_u32 s77, s77, s8
    s_lshl_b32 s78, s80, 14
    s_lshl_b32 s8, s79, 12
    s_add_u32 s78, s78, s8
    s_cmp_ge_u32 s7, 4
    s_cbranch_scc1 p1g
    s_and_b32 s9, s6, 1
    s_lshl_b32 s10, s9, 11
    s_xor_b32 s96, s78, s10
    s_lshr_b32 s11, s4, 3
    s_lshl_b32 s11, s11, 1
    s_add_u32 s11, s11, s9
    s_mul_i32 s9, s9, 14336
    s_add_u32 s94, s77, s9
    s_add_u32 s10, s77, 14336
    s_sub_u32 s95, s10, s9
    v_lshlrev_b32 v21, 7, v1
    s_mov_b32 s12, 0
    s_mov_b32 s13, 11010048
    s_waitcnt lgkmcnt(0)
    s_load_dwordx2 s[42:43], s[40:41], s13
    s_mov_b32 s44, s16
    s_mov_b32 s45, s17
    s_mov_b32 s46, 1835008
    s_mov_b32 s47, 0x20000
    s_mov_b32 s56, s40
    s_mov_b32 s57, s41
    s_mov_b32 s58, 16777216
    s_mov_b32 s59, 0x20000
    s_xor_b32 m0, s96, 0
    s_add_u32 s8, s94, 0
    buffer_load_dwordx4 v11, s[44:47], s8 offen lds
    s_xor_b32 m0, s96, 1024
    s_add_u32 s8, s94, 7168
    buffer_load_dwordx4 v12, s[44:47], s8 offen lds
    s_cmp_eq_u32 s76, 1
    s_cbranch_scc1 xh_7
    s_xor_b32 m0, s96, 8192
    s_add_u32 s8, s94, 128
    buffer_load_dwordx4 v11, s[44:47], s8 offen lds
    s_xor_b32 m0, s96, 9216
    s_add_u32 s8, s94, 7296
    buffer_load_dwordx4 v12, s[44:47], s8 offen lds
xh_7:
    s_cmp_ge_u32 s6, 4
    s_cbranch_scc1 notkv_2
    s_xor_b32 m0, s96, 2048
    s_add_u32 s8, s95, 0
    buffer_load_dwordx4 v11, s[44:47], s8 offen lds
    s_xor_b32 m0, s96, 3072
    s_add_u32 s8, s95, 7168
    buffer_load_dwordx4 v12, s[44:47], s8 offen lds
    s_cmp_eq_u32 s76, 1
    s_cbranch_scc1 xh_8
    s_xor_b32 m0, s96, 10240
    s_add_u32 s8, s95, 128
    buffer_load_dwordx4 v11, s[44:47], s8 offen lds
    s_xor_b32 m0, s96, 11264
    s_add_u32 s8, s95, 7296
    buffer_load_dwordx4 v12, s[44:47], s8 offen lds
xh_8:
    s_bitcmp1_b32 s6, 0
    s_cselect_b32 s52, s22, s20
    s_cselect_b32 s53, s23, s21
    s_mov_b32 s54, 25088
    s_mov_b32 s55, 0x20000
    s_mul_i32 s9, s7, 7168
    s_add_u32 m0, s9, 114688
    s_cmp_eq_u32 s76, 1
    buffer_load_dwordx4 v4, s[52:55], s9 offen offset:0 lds
    buffer_load_dwordx4 v4, s[52:55], s9 offen offset:1024 lds
    buffer_load_dwordx4 v4, s[52:55], s9 offen offset:2048 lds
    buffer_load_dwordx4 v4, s[52:55], s9 offen offset:3072 lds
    s_cbranch_scc1 wk3_9
    s_add_u32 m0, m0, 4096
    s_add_u32 s9, s9, 4096
    buffer_load_dwordx4 v4, s[52:55], s9 offen offset:0 lds
    buffer_load_dwordx4 v4, s[52:55], s9 offen offset:1024 lds
    buffer_load_dwordx4 v4, s[52:55], s9 offen offset:2048 lds
wk3_9:
    s_barrier
    v_lshrrev_b32 v20, 1, v2
    v_and_b32 v20, 7, v20
    v_xor_b32 v20, v20, v3
    v_lshlrev_b32 v20, 4, v20
    v_lshl_add_u32 v14, v2, 7, v20
    v_xor_b32 v15, 32, v14
    v_xor_b32 v16, 64, v14
    v_xor_b32 v17, 96, v14
    v_lshl_add_u32 v20, v3, 3, v8
    v_mul_u32_u24 v18, 56, v20
    v_add_u32 v18, v18, v9
    s_mul_i32 s9, s7, 7168
    s_add_u32 s9, s9, 114688
    v_add_u32 v18, s9, v18
    v_add_u32 v24, s78, v14
    v_xor_b32 v25, 32, v24
    v_xor_b32 v30, 64, v24
    v_xor_b32 v31, 96, v24
    v_mov_b32 v23, 0
    v_mov_b32 v22, 0
    v_mov_b32 v21, 0
    s_lshl_b32 s8, s7, 4
    s_add_u32 s8, s8, 156672
    v_lshlrev_b32 v120, 6, v2
    v_lshl_add_u32 v121, v3, 3, v120
    v_add_u32 v121, s8, v121
    s_lshl_b32 s8, s7, 2
    s_add_u32 s8, s8, 155648
    v_add_u32 v122, s8, v4
    v_add_u32 v123, s9, v4
    s_waitcnt vmcnt(7)
    s_cmp_eq_u32 s76, 1
    s_cbranch_scc0 kv0_10
    s_waitcnt vmcnt(4)
kv0_10:
    ds_read_b128 v[32:35], v24 offset:0
    ds_read_b128 v[36:39], v25 offset:0
    ds_read_b128 v[40:43], v30 offset:0
    ds_read_b128 v[44:47], v31 offset:0
    ds_read_b128 v[48:51], v24 offset:8192
    ds_read_b128 v[52:55], v25 offset:8192
    ds_read_b128 v[56:59], v30 offset:8192
    ds_read_b128 v[60:63], v31 offset:8192
    s_mov_b64 exec, 1
    ds_add_u32 v0, v29 offset:40
    s_mov_b64 exec, -1
    s_waitcnt lgkmcnt(8)
    v_dot2c_f32_bf16 v23, s82, v32
    v_dot2c_f32_bf16 v22, v32, v32
    v_dot2c_f32_bf16 v23, s82, v33
    v_dot2c_f32_bf16 v22, v33, v33
    v_dot2c_f32_bf16 v23, s82, v34
    v_dot2c_f32_bf16 v22, v34, v34
    v_dot2c_f32_bf16 v23, s82, v35
    v_dot2c_f32_bf16 v22, v35, v35
    s_waitcnt lgkmcnt(7)
    v_dot2c_f32_bf16 v23, s82, v36
    v_dot2c_f32_bf16 v22, v36, v36
    v_dot2c_f32_bf16 v23, s82, v37
    v_dot2c_f32_bf16 v22, v37, v37
    v_dot2c_f32_bf16 v23, s82, v38
    v_dot2c_f32_bf16 v22, v38, v38
    v_dot2c_f32_bf16 v23, s82, v39
    v_dot2c_f32_bf16 v22, v39, v39
    s_waitcnt lgkmcnt(6)
    v_dot2c_f32_bf16 v23, s82, v40
    v_dot2c_f32_bf16 v22, v40, v40
    v_dot2c_f32_bf16 v23, s82, v41
    v_dot2c_f32_bf16 v22, v41, v41
    v_dot2c_f32_bf16 v23, s82, v42
    v_dot2c_f32_bf16 v22, v42, v42
    v_dot2c_f32_bf16 v23, s82, v43
    v_dot2c_f32_bf16 v22, v43, v43
    s_waitcnt lgkmcnt(5)
    v_dot2c_f32_bf16 v23, s82, v44
    v_dot2c_f32_bf16 v22, v44, v44
    v_dot2c_f32_bf16 v23, s82, v45
    v_dot2c_f32_bf16 v22, v45, v45
    v_dot2c_f32_bf16 v23, s82, v46
    v_dot2c_f32_bf16 v22, v46, v46
    v_dot2c_f32_bf16 v23, s82, v47
    v_dot2c_f32_bf16 v22, v47, v47
    s_cmp_eq_u32 s76, 1
    s_cbranch_scc1 kv1a_11
    s_waitcnt lgkmcnt(4)
    v_dot2c_f32_bf16 v23, s82, v48
    v_dot2c_f32_bf16 v22, v48, v48
    v_dot2c_f32_bf16 v23, s82, v49
    v_dot2c_f32_bf16 v22, v49, v49
    v_dot2c_f32_bf16 v23, s82, v50
    v_dot2c_f32_bf16 v22, v50, v50
    v_dot2c_f32_bf16 v23, s82, v51
    v_dot2c_f32_bf16 v22, v51, v51
    s_waitcnt lgkmcnt(3)
    v_dot2c_f32_bf16 v23, s82, v52
    v_dot2c_f32_bf16 v22, v52, v52
    v_dot2c_f32_bf16 v23, s82, v53
    v_dot2c_f32_bf16 v22, v53, v53
    v_dot2c_f32_bf16 v23, s82, v54
    v_dot2c_f32_bf16 v22, v54, v54
    v_dot2c_f32_bf16 v23, s82, v55
    v_dot2c_f32_bf16 v22, v55, v55
    s_waitcnt lgkmcnt(2)
    v_dot2c_f32_bf16 v23, s82, v56
    v_dot2c_f32_bf16 v22, v56, v56
    v_dot2c_f32_bf16 v23, s82, v57
    v_dot2c_f32_bf16 v22, v57, v57
    v_dot2c_f32_bf16 v23, s82, v58
    v_dot2c_f32_bf16 v22, v58, v58
    v_dot2c_f32_bf16 v23, s82, v59
    v_dot2c_f32_bf16 v22, v59, v59
    s_waitcnt lgkmcnt(1)
    v_dot2c_f32_bf16 v23, s82, v60
    v_dot2c_f32_bf16 v22, v60, v60
    v_dot2c_f32_bf16 v23, s82, v61
    v_dot2c_f32_bf16 v22, v61, v61
    v_dot2c_f32_bf16 v23, s82, v62
    v_dot2c_f32_bf16 v22, v62, v62
    v_dot2c_f32_bf16 v23, s82, v63
    v_dot2c_f32_bf16 v22, v63, v63
kv1a_11:
    s_waitcnt vmcnt(0) lgkmcnt(0)
    s_nop 1
    ds_write_b64 v121, v[22:23]
    ds_read_b64_tr_b16 v[64:65], v18 offset:0
    ds_read_b64_tr_b16 v[66:67], v18 offset:224
    ds_read_b64_tr_b16 v[68:69], v18 offset:896
    ds_read_b64_tr_b16 v[70:71], v18 offset:1120
    ds_read_b64_tr_b16 v[72:73], v18 offset:1792
    ds_read_b64_tr_b16 v[74:75], v18 offset:2016
    ds_read_b64_tr_b16 v[76:77], v18 offset:2688
    ds_read_b64_tr_b16 v[78:79], v18 offset:2912
    ds_read_b64_tr_b16 v[80:81], v18 offset:3584
    ds_read_b64_tr_b16 v[82:83], v18 offset:3808
    ds_read_b64_tr_b16 v[84:85], v18 offset:4480
    ds_read_b64_tr_b16 v[86:87], v18 offset:4704
    ds_read_b64_tr_b16 v[88:89], v18 offset:5376
    ds_read_b64_tr_b16 v[90:91], v18 offset:5600
    s_waitcnt lgkmcnt(13)
    ds_read_b64_tr_b16 v[92:93], v18 offset:6272
    ds_read_b64_tr_b16 v[94:95], v18 offset:6496
    s_waitcnt lgkmcnt(14)
    v_dot2c_f32_bf16 v21, s82, v64
    v_dot2c_f32_bf16 v21, s82, v65
    v_dot2c_f32_bf16 v21, s82, v66
    v_dot2c_f32_bf16 v21, s82, v67
    s_waitcnt lgkmcnt(12)
    v_dot2c_f32_bf16 v21, s82, v68
    v_dot2c_f32_bf16 v21, s82, v69
    v_dot2c_f32_bf16 v21, s82, v70
    v_dot2c_f32_bf16 v21, s82, v71
    s_waitcnt lgkmcnt(10)
    v_dot2c_f32_bf16 v21, s82, v72
    v_dot2c_f32_bf16 v21, s82, v73
    v_dot2c_f32_bf16 v21, s82, v74
    v_dot2c_f32_bf16 v21, s82, v75
    s_waitcnt lgkmcnt(8)
    v_dot2c_f32_bf16 v21, s82, v76
    v_dot2c_f32_bf16 v21, s82, v77
    v_dot2c_f32_bf16 v21, s82, v78
    v_dot2c_f32_bf16 v21, s82, v79
    s_cmp_eq_u32 s76, 1
    s_cbranch_scc1 kv1c_13
    s_waitcnt lgkmcnt(6)
    v_dot2c_f32_bf16 v21, s82, v80
    v_dot2c_f32_bf16 v21, s82, v81
    v_dot2c_f32_bf16 v21, s82, v82
    v_dot2c_f32_bf16 v21, s82, v83
    s_waitcnt lgkmcnt(4)
    v_dot2c_f32_bf16 v21, s82, v84
    v_dot2c_f32_bf16 v21, s82, v85
    v_dot2c_f32_bf16 v21, s82, v86
    v_dot2c_f32_bf16 v21, s82, v87
    s_waitcnt lgkmcnt(2)
    v_dot2c_f32_bf16 v21, s82, v88
    v_dot2c_f32_bf16 v21, s82, v89
    v_dot2c_f32_bf16 v21, s82, v90
    v_dot2c_f32_bf16 v21, s82, v91
    s_waitcnt lgkmcnt(0)
    v_dot2c_f32_bf16 v21, s82, v92
    v_dot2c_f32_bf16 v21, s82, v93
    v_dot2c_f32_bf16 v21, s82, v94
    v_dot2c_f32_bf16 v21, s82, v95
kv1c_13:
    s_bitcmp1_b32 s6, 0
    s_cbranch_scc1 kvv_14
    v_mfma_f32_32x32x16_bf16 v[96:111], v[64:67], v[32:35], 0
    v_cvt_pk_bf16_f32 v31, v21, v21
    v_and_b32 v31, 0xffff0000, v31
    v_sub_f32 v31, v21, v31
    v_cvt_pk_bf16_f32 v24, v21, v31
    ds_write_b32 v122, v24
    s_mov_b64 exec, 1
    ds_add_u32 v0, v29 offset:56
    s_mov_b64 exec, -1
    v_mfma_f32_32x32x16_bf16 v[96:111], v[68:71], v[36:39], v[96:111]
    v_mfma_f32_32x32x16_bf16 v[96:111], v[72:75], v[40:43], v[96:111]
    v_mfma_f32_32x32x16_bf16 v[96:111], v[76:79], v[44:47], v[96:111]
    s_cmp_eq_u32 s76, 1
    s_cbranch_scc1 kvfin_15
    v_mfma_f32_32x32x16_bf16 v[96:111], v[80:83], v[48:51], v[96:111]
    v_mfma_f32_32x32x16_bf16 v[96:111], v[84:87], v[52:55], v[96:111]
    v_mfma_f32_32x32x16_bf16 v[96:111], v[88:91], v[56:59], v[96:111]
    v_mfma_f32_32x32x16_bf16 v[96:111], v[92:95], v[60:63], v[96:111]
    s_branch kv1b_12
kvv_14:
    v_mfma_f32_32x32x16_bf16 v[96:111], v[32:35], v[64:67], 0
    v_cvt_pk_bf16_f32 v31, v21, v21
    v_and_b32 v31, 0xffff0000, v31
    v_sub_f32 v31, v21, v31
    v_cvt_pk_bf16_f32 v24, v21, v31
    ds_write_b32 v122, v24
    s_mov_b64 exec, 1
    ds_add_u32 v0, v29 offset:56
    s_mov_b64 exec, -1
    v_mfma_f32_32x32x16_bf16 v[96:111], v[36:39], v[68:71], v[96:111]
    v_mfma_f32_32x32x16_bf16 v[96:111], v[40:43], v[72:75], v[96:111]
    v_mfma_f32_32x32x16_bf16 v[96:111], v[44:47], v[76:79], v[96:111]
    s_cmp_eq_u32 s76, 1
    s_cbranch_scc1 kvfin_15
    v_mfma_f32_32x32x16_bf16 v[96:111], v[48:51], v[80:83], v[96:111]
    v_mfma_f32_32x32x16_bf16 v[96:111], v[52:55], v[84:87], v[96:111]
    v_mfma_f32_32x32x16_bf16 v[96:111], v[56:59], v[88:91], v[96:111]
    v_mfma_f32_32x32x16_bf16 v[96:111], v[60:63], v[92:95], v[96:111]
kv1b_12:
    s_lshl_b32 s10, s79, 1
    s_xor_b32 s10, s10, 2
    s_add_u32 s10, s10, s7
    s_waitcnt lgkmcnt(0)
    s_mul_i32 s42, s42, 0x9e3779b5
    s_mul_i32 s43, s43, 0x85ebca6d
    s_add_u32 s42, s42, 0x7f4a7c15
    s_add_u32 s43, s43, 0x165667b1
    s_nop 3
    ds_write_b128 v123, v[96:99] offset:0
    ds_write_b128 v123, v[100:103] offset:1024
    ds_write_b128 v123, v[104:107] offset:2048
    ds_write_b128 v123, v[108:111] offset:3072
    s_mov_b64 exec, 1
    ds_add_u32 v0, v29 offset:4
    s_mov_b64 exec, -1
    s_cmp_lt_u32 s7, 2
    s_cbranch_scc1 dostats_5
    s_mov_b64 exec, 1
    ds_add_u32 v0, v29 offset:12
    s_mov_b64 exec, -1
    s_branch qgo_4
kvfin_15:
    s_setprio 3
    v_add_u32 v24, 156672, v120
    v_add_u32 v25, 114688, v4
    v_add_u32 v21, 155648, v4
    s_lshl_b32 s9, s5, 1
    s_add_u32 s9, s9, s79
    s_lshl_b32 s9, s9, 12
    s_add_u32 s9, s9, 2097152
    s_lshl_b32 s12, s5, 2
    s_add_u32 s12, s12, s6
    s_lshl_b32 s12, s12, 6
    s_add_u32 s12, s12, 10616832
    s_lshl_b32 s8, s79, 8
    s_add_u32 s8, s8, 158720
    v_lshl_add_u32 v30, v2, 3, s8
    s_waitcnt vmcnt(0)
    s_waitcnt lgkmcnt(0)
    s_mul_i32 s42, s42, 0x9e3779b5
    s_mul_i32 s43, s43, 0x85ebca6d
    s_add_u32 s42, s42, 0x7f4a7c15
    s_add_u32 s43, s43, 0x165667b1
    s_branch spe_21
spin_20:
    s_sleep 1
spe_21:
    ds_read_b32 v28, v0 offset:56
    s_waitcnt lgkmcnt(0)
    v_readfirstlane_b32 s13, v28
    s_cmp_lt_u32 s13, 4
    s_cbranch_scc1 spin_20
    ds_read_b128 v[32:35], v24 offset:0
    ds_read_b128 v[36:39], v24 offset:16
    ds_read_b128 v[40:43], v24 offset:32
    ds_read_b128 v[44:47], v24 offset:48
    ds_read_b128 v[112:115], v21
    s_waitcnt lgkmcnt(1)
    v_pk_add_f32 v[32:33], v[32:33], v[34:35]
    v_pk_add_f32 v[36:37], v[36:37], v[38:39]
    v_pk_add_f32 v[40:41], v[40:41], v[42:43]
    v_pk_add_f32 v[44:45], v[44:45], v[46:47]
    v_pk_add_f32 v[32:33], v[32:33], v[36:37]
    v_pk_add_f32 v[40:41], v[40:41], v[44:45]
    v_pk_add_f32 v[32:33], v[32:33], v[40:41]
    v_mul_f32 v33, 0x3b124925, v33
    v_mul_f32 v32, 0x3b124925, v32
    v_fma_f32 v32, -v33, v33, v32
    v_max_f32 v32, 0, v32
    v_cvt_pk_bf16_f32 v21, v33, v32
    v_lshlrev_b32 v22, 16, v21
    v_and_b32 v21, 0xffff0000, v21
    v_add_f32 v21, 0x3727c5ac, v21
    v_cvt_pk_bf16_f32 v21, v21, v21
    v_and_b32 v21, 0xffff0000, v21
    v_sqrt_f32 v21, v21
    s_nop 0
    v_cvt_pk_bf16_f32 v21, v21, v21
    v_and_b32 v21, 0xffff0000, v21
    v_rcp_f32 v23, v21
    s_nop 0
    v_cvt_pk_bf16_f32 v116, -v22, -v22
    v_lshlrev_b32 v21, 2, v2
    v_add_u32 v21, 159232, v21
    ds_write_b32 v21, v23
    v_mul_f32 v117, 0x3e8b97f6, v23
    v_lshlrev_b32 v21, 4, v3
    v_add_u32 v21, 159232, v21
    ds_write_b64 v30, v[116:117]
    v_mov_b32 v118, v116
    v_mov_b32 v119, v116
    v_mov_b32 v22, v23
    s_mov_b64 exec, 1
    ds_add_u32 v0, v29 offset:12
    s_mov_b64 exec, -1
    s_waitcnt lgkmcnt(0)
    v_mov_b32 v117, v116
    s_bitcmp1_b32 s6, 0
    s_cbranch_scc1 vfin_16
    v_mfma_f32_32x32x16_bf16 v[96:111], v[112:115], v[116:119], v[96:111]
    s_branch kvcm_19
vfin_16:
    v_mfma_f32_32x32x16_bf16 v[96:111], v[116:119], v[112:115], v[96:111]
    ds_read_b128 v[32:35], v21 offset:0
    ds_read_b128 v[36:39], v21 offset:32
    ds_read_b128 v[40:43], v21 offset:64
    ds_read_b128 v[44:47], v21 offset:96
    s_add_u32 s9, s9, 2048
    v_cmp_eq_u32 vcc, 28, v2
    v_mov_b32 v24, 0x3f803f80
    s_nop 1
    v_cndmask_b32 v24, 0, v24, vcc
    v_mov_b32 v120, v24
    v_mov_b32 v121, v24
    v_mov_b32 v122, v24
    v_mov_b32 v123, v24
    v_mov_b32 v124, v24
    v_mov_b32 v125, v24
    v_mov_b32 v126, v24
    v_mov_b32 v127, v24
kvcm_19:
    s_branch spe_23
spin_22:
    s_sleep 1
spe_23:
    ds_read_b32 v28, v0 offset:4
    s_waitcnt lgkmcnt(0)
    v_readfirstlane_b32 s13, v28
    s_cmp_lt_u32 s13, 3
    s_cbranch_scc1 spin_22
    ds_read_b128 v[128:131], v25 offset:0
    ds_read_b128 v[132:135], v25 offset:1024
    ds_read_b128 v[136:139], v25 offset:2048
    ds_read_b128 v[140:143], v25 offset:3072
    ds_read_b128 v[144:147], v25 offset:7168
    ds_read_b128 v[148:151], v25 offset:8192
    ds_read_b128 v[152:155], v25 offset:9216
    ds_read_b128 v[156:159], v25 offset:10240
    ds_read_b128 v[160:163], v25 offset:14336
    ds_read_b128 v[164:167], v25 offset:15360
    ds_read_b128 v[168:171], v25 offset:16384
    ds_read_b128 v[172:175], v25 offset:17408
    s_waitcnt lgkmcnt(8)
    v_pk_add_f32 v[96:97], v[96:97], v[128:129]
    v_pk_add_f32 v[98:99], v[98:99], v[130:131]
    v_pk_add_f32 v[100:101], v[100:101], v[132:133]
    v_pk_add_f32 v[102:103], v[102:103], v[134:135]
    v_pk_add_f32 v[104:105], v[104:105], v[136:137]
    v_pk_add_f32 v[106:107], v[106:107], v[138:139]
    v_pk_add_f32 v[108:109], v[108:109], v[140:141]
    v_pk_add_f32 v[110:111], v[110:111], v[142:143]
    s_waitcnt lgkmcnt(4)
    v_pk_add_f32 v[96:97], v[96:97], v[144:145]
    v_pk_add_f32 v[98:99], v[98:99], v[146:147]
    v_pk_add_f32 v[100:101], v[100:101], v[148:149]
    v_pk_add_f32 v[102:103], v[102:103], v[150:151]
    v_pk_add_f32 v[104:105], v[104:105], v[152:153]
    v_pk_add_f32 v[106:107], v[106:107], v[154:155]
    v_pk_add_f32 v[108:109], v[108:109], v[156:157]
    v_pk_add_f32 v[110:111], v[110:111], v[158:159]
    s_waitcnt lgkmcnt(0)
    v_pk_add_f32 v[96:97], v[96:97], v[160:161]
    v_pk_add_f32 v[98:99], v[98:99], v[162:163]
    v_pk_add_f32 v[100:101], v[100:101], v[164:165]
    v_pk_add_f32 v[102:103], v[102:103], v[166:167]
    v_pk_add_f32 v[104:105], v[104:105], v[168:169]
    v_pk_add_f32 v[106:107], v[106:107], v[170:171]
    v_pk_add_f32 v[108:109], v[108:109], v[172:173]
    v_pk_add_f32 v[110:111], v[110:111], v[174:175]
    s_bitcmp1_b32 s6, 0
    s_cbranch_scc1 vf2_18
    v_pk_mul_f32 v[96:97], v[96:97], v[22:23]
    v_pk_mul_f32 v[98:99], v[98:99], v[22:23]
    v_pk_mul_f32 v[100:101], v[100:101], v[22:23]
    v_pk_mul_f32 v[102:103], v[102:103], v[22:23]
    v_pk_mul_f32 v[104:105], v[104:105], v[22:23]
    v_pk_mul_f32 v[106:107], v[106:107], v[22:23]
    v_pk_mul_f32 v[108:109], v[108:109], v[22:23]
    v_pk_mul_f32 v[110:111], v[110:111], v[22:23]
    v_cvt_pk_bf16_f32 v120, v96, v97
    v_cvt_pk_bf16_f32 v121, v98, v99
    v_cvt_pk_bf16_f32 v122, v100, v101
    v_cvt_pk_bf16_f32 v123, v102, v103
    v_cvt_pk_bf16_f32 v124, v104, v105
    v_cvt_pk_bf16_f32 v125, v106, v107
    v_cvt_pk_bf16_f32 v126, v108, v109
    v_cvt_pk_bf16_f32 v127, v110, v111
    s_mov_b64 exec, s[14:15]
    v_mov_b32 v126, 0x3f803f80
    v_mov_b32 v127, 0x00003f80
    s_branch kvst_17
vf2_18:
    s_mov_b32 exec_lo, 0x0fffffff
    s_mov_b32 exec_hi, 0x0fffffff
    v_pk_mul_f32 v[96:97], v[96:97], v[32:33]
    v_pk_mul_f32 v[98:99], v[98:99], v[34:35]
    v_pk_mul_f32 v[100:101], v[100:101], v[36:37]
    v_pk_mul_f32 v[102:103], v[102:103], v[38:39]
    v_pk_mul_f32 v[104:105], v[104:105], v[40:41]
    v_pk_mul_f32 v[106:107], v[106:107], v[42:43]
    v_pk_mul_f32 v[108:109], v[108:109], v[44:45]
    v_pk_mul_f32 v[110:111], v[110:111], v[46:47]
    v_cvt_pk_bf16_f32 v120, v96, v97
    v_cvt_pk_bf16_f32 v121, v98, v99
    v_cvt_pk_bf16_f32 v122, v100, v101
    v_cvt_pk_bf16_f32 v123, v102, v103
    v_cvt_pk_bf16_f32 v124, v104, v105
    v_cvt_pk_bf16_f32 v125, v106, v107
    v_cvt_pk_bf16_f32 v126, v108, v109
    v_cvt_pk_bf16_f32 v127, v110, v111
kvst_17:
    s_mov_b64 exec, -1
    buffer_store_dwordx4 v[120:123], v4, s[56:59], s9 offen sc1
    buffer_store_dwordx4 v[124:127], v4, s[56:59], s9 offen offset:1024 sc1
    s_mov_b64 exec, 1
    ds_add_u32 v0, v29 offset:48
    s_mov_b64 exec, -1
    s_branch qgo_4
notkv_2:
    s_lshr_b32 s11, s4, 3
    s_lshl_b32 s11, s11, 2
    s_add_u32 s11, s11, s6
    s_sub_u32 s11, s11, 4
    s_lshl_b32 s8, s11, 2
    s_add_u32 s8, s8, s7
    s_cmp_eq_u32 s11, 1
    s_cselect_b32 s52, s22, s20
    s_cselect_b32 s53, s23, s21
    s_mov_b32 s54, 401408
    s_sub_u32 s9, s8, 8
    s_cmp_lt_u32 s11, 2
    s_cselect_b32 s52, s52, s18
    s_cselect_b32 s53, s53, s19
    s_cselect_b32 s54, 25088, s54
    s_cselect_b32 s9, s7, s9
    s_mov_b32 s55, 0x20000
    s_lshl_b32 s9, s9, 13
    buffer_load_dword v250, v21, s[52:55], s9 offen
    v_min_u32 v14, 6, v6
    v_mul_u32_u24 v246, 3584, v5
    v_lshl_add_u32 v246, v14, 7, v246
    s_lshl_b32 s9, s80, 6
    s_lshr_b32 s10, s4, 3
    s_lshl_b32 s10, s10, 1
    s_add_u32 s9, s9, s10
    s_and_b32 s10, s6, 1
    s_add_u32 s9, s9, s10
    s_sub_u32 s9, s9, 1
    s_mul_i32 s99, s9, 28672
    s_lshr_b32 s10, s3, 1
    s_mul_i32 s10, s10, 896
    s_add_u32 s99, s99, s10
    s_mov_b32 s60, s28
    s_mov_b32 s61, s29
    s_mov_b32 s62, 7340032
    s_mov_b32 s63, 0x20000
    v_lshrrev_b32 v20, 1, v2
    v_and_b32 v20, 7, v20
    v_xor_b32 v20, v20, v3
    v_lshlrev_b32 v20, 4, v20
    v_lshl_add_u32 v14, v2, 7, v20
    v_xor_b32 v15, 32, v14
    v_xor_b32 v16, 64, v14
    v_xor_b32 v17, 96, v14
    v_lshl_add_u32 v20, v3, 3, v8
    s_mov_b32 s10, s7
    s_barrier
    s_waitcnt vmcnt(1)
    s_mov_b64 exec, 1
    ds_add_u32 v0, v29 offset:40
    s_mov_b64 exec, -1
    s_mov_b32 s48, s18
    s_mov_b32 s49, s19
    s_mov_b32 s50, 401408
    s_mov_b32 s51, 0x20000
    s_xor_b32 s27, s78, 4096
    s_mul_i32 s8, s79, 57344
    s_add_u32 s26, s77, 28672
    s_sub_u32 s26, s26, s8
    s_mul_i32 s38, s80, 114688
    s_mul_i32 s8, s6, 112
    s_add_u32 s38, s38, s8
    s_lshl_b32 s39, s80, 14
    s_cmp_lt_u32 s6, 6
    s_cbranch_scc1 noearly_24
    s_cmp_eq_u32 s4, 6
    s_cbranch_scc1 noearly_24
    buffer_load_dword v251, v246, s[60:63], s99 offen
    s_add_u32 s99, s99, 200704
nowait_25:
    s_branch spe_27
spin_26:
    s_sleep 1
spe_27:
    ds_read_b32 v28, v0 offset:48
    s_waitcnt lgkmcnt(0)
    v_readfirstlane_b32 s13, v28
    s_cmp_lt_u32 s13, 4
    s_cbranch_scc1 spin_26
noearly_24:
    s_xor_b32 m0, s96, 2048
    s_add_u32 s8, s95, 0
    buffer_load_dwordx4 v11, s[44:47], s8 offen lds
    s_xor_b32 m0, s96, 3072
    s_add_u32 s8, s95, 7168
    buffer_load_dwordx4 v12, s[44:47], s8 offen lds
    s_cmp_eq_u32 s76, 1
    s_cbranch_scc1 xh_28
    s_xor_b32 m0, s96, 10240
    s_add_u32 s8, s95, 128
    buffer_load_dwordx4 v11, s[44:47], s8 offen lds
    s_xor_b32 m0, s96, 11264
    s_add_u32 s8, s95, 7296
    buffer_load_dwordx4 v12, s[44:47], s8 offen lds
xh_28:
    s_add_u32 m0, s27, 0
    s_add_u32 s8, s26, 0
    buffer_load_dwordx4 v11, s[44:47], s8 offen lds
    s_add_u32 m0, s27, 1024
    s_add_u32 s8, s26, 7168
    buffer_load_dwordx4 v12, s[44:47], s8 offen lds
    s_add_u32 m0, s27, 2048
    s_add_u32 s8, s26, 14336
    buffer_load_dwordx4 v11, s[44:47], s8 offen lds
    s_add_u32 m0, s27, 3072
    s_add_u32 s8, s26, 21504
    buffer_load_dwordx4 v12, s[44:47], s8 offen lds
    s_cmp_eq_u32 s76, 1
    s_cbranch_scc1 rd1_29
    s_add_u32 m0, s27, 8192
    s_add_u32 s8, s26, 128
    buffer_load_dwordx4 v11, s[44:47], s8 offen lds
    s_add_u32 m0, s27, 9216
    s_add_u32 s8, s26, 7296
    buffer_load_dwordx4 v12, s[44:47], s8 offen lds
    s_add_u32 m0, s27, 10240
    s_add_u32 s8, s26, 14464
    buffer_load_dwordx4 v11, s[44:47], s8 offen lds
    s_add_u32 m0, s27, 11264
    s_add_u32 s8, s26, 21632
    buffer_load_dwordx4 v12, s[44:47], s8 offen lds
rd1_29:
    s_add_u32 m0, s39, 57344
    s_add_u32 s8, s38, 0
    buffer_load_dwordx4 v13, s[48:51], s8 offen lds
    s_add_u32 m0, s39, 58368
    s_add_u32 s8, s38, 7168
    buffer_load_dwordx4 v13, s[48:51], s8 offen lds
    s_add_u32 m0, s39, 59392
    s_add_u32 s8, s38, 14336
    buffer_load_dwordx4 v13, s[48:51], s8 offen lds
    s_add_u32 m0, s39, 60416
    s_add_u32 s8, s38, 21504
    buffer_load_dwordx4 v13, s[48:51], s8 offen lds
    s_add_u32 m0, s39, 61440
    s_add_u32 s8, s38, 28672
    buffer_load_dwordx4 v13, s[48:51], s8 offen lds
    s_add_u32 m0, s39, 62464
    s_add_u32 s8, s38, 35840
    buffer_load_dwordx4 v13, s[48:51], s8 offen lds
    s_add_u32 m0, s39, 63488
    s_add_u32 s8, s38, 43008
    buffer_load_dwordx4 v13, s[48:51], s8 offen lds
    s_add_u32 m0, s39, 64512
    s_add_u32 s8, s38, 50176
    buffer_load_dwordx4 v13, s[48:51], s8 offen lds
    s_waitcnt vmcnt(8)
    s_mov_b64 exec, 1
    ds_add_u32 v0, v29 offset:44
    s_mov_b64 exec, -1
    s_cmp_eq_u32 s76, 1
    s_cbranch_scc1 rd2_30
    s_add_u32 m0, s39, 65536
    s_add_u32 s8, s38, 57344
    buffer_load_dwordx4 v13, s[48:51], s8 offen lds
    s_add_u32 m0, s39, 66560
    s_add_u32 s8, s38, 64512
    buffer_load_dwordx4 v13, s[48:51], s8 offen lds
    s_add_u32 m0, s39, 67584
    s_add_u32 s8, s38, 71680
    buffer_load_dwordx4 v13, s[48:51], s8 offen lds
    s_add_u32 m0, s39, 68608
    s_add_u32 s8, s38, 78848
    buffer_load_dwordx4 v13, s[48:51], s8 offen lds
    s_add_u32 m0, s39, 69632
    s_add_u32 s8, s38, 86016
    buffer_load_dwordx4 v13, s[48:51], s8 offen lds
    s_add_u32 m0, s39, 70656
    s_add_u32 s8, s38, 93184
    buffer_load_dwordx4 v13, s[48:51], s8 offen lds
    s_add_u32 m0, s39, 71680
    s_add_u32 s8, s38, 100352
    buffer_load_dwordx4 v13, s[48:51], s8 offen lds
    s_add_u32 m0, s39, 72704
    s_add_u32 s8, s38, 107520
    buffer_load_dwordx4 v13, s[48:51], s8 offen lds
rd2_30:
    s_mov_b64 exec, 1
    ds_add_u32 v0, v29 offset:20
    s_mov_b64 exec, -1
    s_waitcnt lgkmcnt(0)
    s_mul_i32 s42, s42, 0x9e3779b5
    s_mul_i32 s43, s43, 0x85ebca6d
    s_add_u32 s42, s42, 0x7f4a7c15
    s_add_u32 s43, s43, 0x165667b1
    s_cmp_lt_u32 s6, 6
    s_cbranch_scc1 dostats_5
    s_and_b32 s8, s2, 0xf9
    s_cmp_lg_u32 s8, 48
    s_cbranch_scc1 poststats_6
dostats_5:
    v_lshrrev_b32 v40, 2, v1
    v_and_b32 v41, 3, v1
    v_lshlrev_b32 v41, 5, v41
    v_lshl_add_u32 v41, v40, 7, v41
    v_lshlrev_b32 v42, 1, v1
    v_and_b32 v42, 16, v42
    v_add_u32 v41, v41, v42
    s_lshl_b32 s8, s10, 11
    v_add_u32 v41, s8, v41
    v_xor_b32 v43, 16, v41
    s_lshl_b32 s8, s10, 7
    s_add_u32 s8, s8, 158720
    v_lshl_add_u32 v40, v40, 3, s8
    v_mov_b32 v44, 0
    v_mov_b32 v45, 0
    s_branch spe_32
spin_31:
    s_sleep 1
spe_32:
    ds_read_b32 v28, v0 offset:40
    s_waitcnt lgkmcnt(0)
    v_readfirstlane_b32 s13, v28
    s_cmp_lt_u32 s13, 4
    s_cbranch_scc1 spin_31
    s_branch spe_34
spin_33:
    s_sleep 1
spe_34:
    ds_read_b32 v28, v0 offset:44
    s_waitcnt lgkmcnt(0)
    v_readfirstlane_b32 s13, v28
    s_cmp_lt_u32 s13, 4
    s_cbranch_scc1 spin_33
    ds_read_b128 v[128:131], v41 offset:0
    ds_read_b128 v[132:135], v43 offset:0
    ds_read_b128 v[136:139], v41 offset:8192
    ds_read_b128 v[140:143], v43 offset:8192
    ds_read_b128 v[144:147], v41 offset:16384
    ds_read_b128 v[148:151], v43 offset:16384
    ds_read_b128 v[152:155], v41 offset:24576
    ds_read_b128 v[156:159], v43 offset:24576
    ds_read_b128 v[160:163], v41 offset:32768
    ds_read_b128 v[164:167], v43 offset:32768
    ds_read_b128 v[168:171], v41 offset:40960
    ds_read_b128 v[172:175], v43 offset:40960
    ds_read_b128 v[176:179], v41 offset:49152
    ds_read_b128 v[180:183], v43 offset:49152
    s_waitcnt lgkmcnt(12)
    v_dot2c_f32_bf16 v44, s82, v128
    v_dot2c_f32_bf16 v45, v128, v128
    v_dot2c_f32_bf16 v44, s82, v129
    v_dot2c_f32_bf16 v45, v129, v129
    v_dot2c_f32_bf16 v44, s82, v130
    v_dot2c_f32_bf16 v45, v130, v130
    v_dot2c_f32_bf16 v44, s82, v131
    v_dot2c_f32_bf16 v45, v131, v131
    v_dot2c_f32_bf16 v44, s82, v132
    v_dot2c_f32_bf16 v45, v132, v132
    v_dot2c_f32_bf16 v44, s82, v133
    v_dot2c_f32_bf16 v45, v133, v133
    v_dot2c_f32_bf16 v44, s82, v134
    v_dot2c_f32_bf16 v45, v134, v134
    v_dot2c_f32_bf16 v44, s82, v135
    v_dot2c_f32_bf16 v45, v135, v135
    s_waitcnt lgkmcnt(10)
    v_dot2c_f32_bf16 v44, s82, v136
    v_dot2c_f32_bf16 v45, v136, v136
    v_dot2c_f32_bf16 v44, s82, v137
    v_dot2c_f32_bf16 v45, v137, v137
    v_dot2c_f32_bf16 v44, s82, v138
    v_dot2c_f32_bf16 v45, v138, v138
    v_dot2c_f32_bf16 v44, s82, v139
    v_dot2c_f32_bf16 v45, v139, v139
    v_dot2c_f32_bf16 v44, s82, v140
    v_dot2c_f32_bf16 v45, v140, v140
    v_dot2c_f32_bf16 v44, s82, v141
    v_dot2c_f32_bf16 v45, v141, v141
    v_dot2c_f32_bf16 v44, s82, v142
    v_dot2c_f32_bf16 v45, v142, v142
    v_dot2c_f32_bf16 v44, s82, v143
    v_dot2c_f32_bf16 v45, v143, v143
    s_waitcnt lgkmcnt(8)
    v_dot2c_f32_bf16 v44, s82, v144
    v_dot2c_f32_bf16 v45, v144, v144
    v_dot2c_f32_bf16 v44, s82, v145
    v_dot2c_f32_bf16 v45, v145, v145
    v_dot2c_f32_bf16 v44, s82, v146
    v_dot2c_f32_bf16 v45, v146, v146
    v_dot2c_f32_bf16 v44, s82, v147
    v_dot2c_f32_bf16 v45, v147, v147
    v_dot2c_f32_bf16 v44, s82, v148
    v_dot2c_f32_bf16 v45, v148, v148
    v_dot2c_f32_bf16 v44, s82, v149
    v_dot2c_f32_bf16 v45, v149, v149
    v_dot2c_f32_bf16 v44, s82, v150
    v_dot2c_f32_bf16 v45, v150, v150
    v_dot2c_f32_bf16 v44, s82, v151
    v_dot2c_f32_bf16 v45, v151, v151
    s_waitcnt lgkmcnt(6)
    v_dot2c_f32_bf16 v44, s82, v152
    v_dot2c_f32_bf16 v45, v152, v152
    v_dot2c_f32_bf16 v44, s82, v153
    v_dot2c_f32_bf16 v45, v153, v153
    v_dot2c_f32_bf16 v44, s82, v154
    v_dot2c_f32_bf16 v45, v154, v154
    v_dot2c_f32_bf16 v44, s82, v155
    v_dot2c_f32_bf16 v45, v155, v155
    v_dot2c_f32_bf16 v44, s82, v156
    v_dot2c_f32_bf16 v45, v156, v156
    v_dot2c_f32_bf16 v44, s82, v157
    v_dot2c_f32_bf16 v45, v157, v157
    v_dot2c_f32_bf16 v44, s82, v158
    v_dot2c_f32_bf16 v45, v158, v158
    v_dot2c_f32_bf16 v44, s82, v159
    v_dot2c_f32_bf16 v45, v159, v159
    s_waitcnt lgkmcnt(4)
    v_dot2c_f32_bf16 v44, s82, v160
    v_dot2c_f32_bf16 v45, v160, v160
    v_dot2c_f32_bf16 v44, s82, v161
    v_dot2c_f32_bf16 v45, v161, v161
    v_dot2c_f32_bf16 v44, s82, v162
    v_dot2c_f32_bf16 v45, v162, v162
    v_dot2c_f32_bf16 v44, s82, v163
    v_dot2c_f32_bf16 v45, v163, v163
    v_dot2c_f32_bf16 v44, s82, v164
    v_dot2c_f32_bf16 v45, v164, v164
    v_dot2c_f32_bf16 v44, s82, v165
    v_dot2c_f32_bf16 v45, v165, v165
    v_dot2c_f32_bf16 v44, s82, v166
    v_dot2c_f32_bf16 v45, v166, v166
    v_dot2c_f32_bf16 v44, s82, v167
    v_dot2c_f32_bf16 v45, v167, v167
    s_waitcnt lgkmcnt(2)
    v_dot2c_f32_bf16 v44, s82, v168
    v_dot2c_f32_bf16 v45, v168, v168
    v_dot2c_f32_bf16 v44, s82, v169
    v_dot2c_f32_bf16 v45, v169, v169
    v_dot2c_f32_bf16 v44, s82, v170
    v_dot2c_f32_bf16 v45, v170, v170
    v_dot2c_f32_bf16 v44, s82, v171
    v_dot2c_f32_bf16 v45, v171, v171
    v_dot2c_f32_bf16 v44, s82, v172
    v_dot2c_f32_bf16 v45, v172, v172
    v_dot2c_f32_bf16 v44, s82, v173
    v_dot2c_f32_bf16 v45, v173, v173
    v_dot2c_f32_bf16 v44, s82, v174
    v_dot2c_f32_bf16 v45, v174, v174
    v_dot2c_f32_bf16 v44, s82, v175
    v_dot2c_f32_bf16 v45, v175, v175
    s_waitcnt lgkmcnt(0)
    v_dot2c_f32_bf16 v44, s82, v176
    v_dot2c_f32_bf16 v45, v176, v176
    v_dot2c_f32_bf16 v44, s82, v177
    v_dot2c_f32_bf16 v45, v177, v177
    v_dot2c_f32_bf16 v44, s82, v178
    v_dot2c_f32_bf16 v45, v178, v178
    v_dot2c_f32_bf16 v44, s82, v179
    v_dot2c_f32_bf16 v45, v179, v179
    v_dot2c_f32_bf16 v44, s82, v180
    v_dot2c_f32_bf16 v45, v180, v180
    v_dot2c_f32_bf16 v44, s82, v181
    v_dot2c_f32_bf16 v45, v181, v181
    v_dot2c_f32_bf16 v44, s82, v182
    v_dot2c_f32_bf16 v45, v182, v182
    v_dot2c_f32_bf16 v44, s82, v183
    v_dot2c_f32_bf16 v45, v183, v183
    s_nop 2
    v_add_f32_dpp v44, v44, v44 quad_perm:[1,0,3,2] row_mask:0xf bank_mask:0xf
    v_add_f32_dpp v45, v45, v45 quad_perm:[1,0,3,2] row_mask:0xf bank_mask:0xf
    s_nop 0
    v_add_f32_dpp v44, v44, v44 quad_perm:[2,3,0,1] row_mask:0xf bank_mask:0xf
    v_add_f32_dpp v45, v45, v45 quad_perm:[2,3,0,1] row_mask:0xf bank_mask:0xf
    s_nop 0
    v_mul_f32 v44, 0x3b124925, v44
    v_mul_f32 v45, 0x3b124925, v45
    v_fma_f32 v45, -v44, v44, v45
    v_max_f32 v45, 0, v45
    v_cvt_pk_bf16_f32 v42, v44, v45
    v_lshlrev_b32 v43, 16, v42
    v_and_b32 v42, 0xffff0000, v42
    v_add_f32 v42, 0x3727c5ac, v42
    v_cvt_pk_bf16_f32 v42, v42, v42
    v_and_b32 v42, 0xffff0000, v42
    v_sqrt_f32 v42, v42
    s_nop 0
    v_cvt_pk_bf16_f32 v42, v42, v42
    v_and_b32 v42, 0xffff0000, v42
    v_rcp_f32 v47, v42
    s_nop 0
    v_cvt_pk_bf16_f32 v46, -v43, -v43
    v_mul_f32 v47, 0x3e8b97f6, v47
    ds_write_b64 v40, v[46:47]
    s_mov_b64 exec, 1
    ds_add_u32 v0, v29 offset:12
    s_mov_b64 exec, -1
    s_cmp_lt_u32 s6, 4
    s_cbranch_scc1 qgo_4
poststats_6:
    s_waitcnt vmcnt(0)
    s_mov_b64 exec, 1
    ds_add_u32 v0, v29 offset:0
    s_mov_b64 exec, -1
qgo_4:
    s_and_b32 s8, s7, 1
    s_mul_i32 s8, s8, 56
    v_add_u32 v19, s8, v9
    v_lshlrev_b32 v21, 5, v8
    v_and_b32 v21, 64, v21
    v_xor_b32 v19, v19, v21
    v_lshl_add_u32 v19, v20, 7, v19
    v_add_u32 v19, 57344, v19
    s_lshr_b32 s9, s7, 1
    s_lshl_b32 s8, s9, 12
    v_mov_b32 v23, 0
    v_mov_b32 v113, 0
    v_mov_b32 v114, 0
    v_mov_b32 v115, 0
    v_mov_b32 v118, 0
    v_mov_b32 v119, 0
    v_add_u32 v14, s8, v14
    v_add_u32 v15, s8, v15
    v_add_u32 v16, s8, v16
    v_add_u32 v17, s8, v17
    s_lshl_b32 s9, s9, 8
    s_add_u32 s9, s9, 158720
    v_lshl_add_u32 v24, v2, 3, s9
    s_branch spe_36
spin_35:
    s_sleep 1
spe_36:
    ds_read_b32 v28, v0 offset:40
    s_waitcnt lgkmcnt(0)
    v_readfirstlane_b32 s13, v28
    s_cmp_lt_u32 s13, 4
    s_cbranch_scc1 spin_35
    s_branch spe_38
spin_37:
    s_sleep 1
spe_38:
    ds_read_b32 v28, v0 offset:0
    s_waitcnt lgkmcnt(0)
    v_readfirstlane_b32 s13, v28
    s_cmp_lt_u32 s13, 4
    s_cbranch_scc1 spin_37
    ds_read_b64_tr_b16 v[64:65], v19 offset:0
    ds_read_b64_tr_b16 v[66:67], v19 offset:512
    ds_read_b128 v[32:35], v14 offset:0
    ds_read_b64_tr_b16 v[68:69], v19 offset:2048
    ds_read_b64_tr_b16 v[70:71], v19 offset:2560
    ds_read_b128 v[36:39], v15 offset:0
    ds_read_b64_tr_b16 v[72:73], v19 offset:4096
    ds_read_b64_tr_b16 v[74:75], v19 offset:4608
    ds_read_b128 v[40:43], v16 offset:0
    ds_read_b64_tr_b16 v[76:77], v19 offset:6144
    ds_read_b64_tr_b16 v[78:79], v19 offset:6656
    ds_read_b128 v[44:47], v17 offset:0
    ds_read_b64_tr_b16 v[80:81], v19 offset:8192
    ds_read_b64_tr_b16 v[82:83], v19 offset:8704
    ds_read_b128 v[48:51], v14 offset:8192
    s_waitcnt lgkmcnt(12)
    v_mfma_f32_32x32x16_bf16 v[128:143], v[64:67], v[32:35], 0
    ds_read_b64_tr_b16 v[84:85], v19 offset:10240
    ds_read_b64_tr_b16 v[86:87], v19 offset:10752
    ds_read_b128 v[52:55], v15 offset:8192
    s_waitcnt lgkmcnt(12)
    v_mfma_f32_32x32x16_bf16 v[128:143], v[68:71], v[36:39], v[128:143]
    ds_read_b64_tr_b16 v[88:89], v19 offset:12288
    ds_read_b64_tr_b16 v[90:91], v19 offset:12800
    ds_read_b128 v[56:59], v16 offset:8192
    s_waitcnt lgkmcnt(12)
    v_mfma_f32_32x32x16_bf16 v[128:143], v[72:75], v[40:43], v[128:143]
    ds_read_b64_tr_b16 v[92:93], v19 offset:14336
    ds_read_b64_tr_b16 v[94:95], v19 offset:14848
    ds_read_b128 v[60:63], v17 offset:8192
    s_waitcnt lgkmcnt(12)
    v_mfma_f32_32x32x16_bf16 v[128:143], v[76:79], v[44:47], v[128:143]
    ds_read_b64_tr_b16 v[96:97], v19 offset:16384
    ds_read_b64_tr_b16 v[98:99], v19 offset:16896
    ds_read_b128 v[32:35], v14 offset:16384
    s_waitcnt lgkmcnt(12)
    v_mfma_f32_32x32x16_bf16 v[128:143], v[80:83], v[48:51], v[128:143]
    ds_read_b64_tr_b16 v[100:101], v19 offset:18432
    ds_read_b64_tr_b16 v[102:103], v19 offset:18944
    ds_read_b128 v[36:39], v15 offset:16384
    s_waitcnt lgkmcnt(12)
    v_mfma_f32_32x32x16_bf16 v[128:143], v[84:87], v[52:55], v[128:143]
    ds_read_b64_tr_b16 v[104:105], v19 offset:20480
    ds_read_b64_tr_b16 v[106:107], v19 offset:20992
    ds_read_b128 v[40:43], v16 offset:16384
    s_waitcnt lgkmcnt(12)
    v_mfma_f32_32x32x16_bf16 v[128:143], v[88:91], v[56:59], v[128:143]
    ds_read_b64_tr_b16 v[108:109], v19 offset:22528
    ds_read_b64_tr_b16 v[110:111], v19 offset:23040
    ds_read_b128 v[44:47], v17 offset:16384
    s_waitcnt lgkmcnt(12)
    v_mfma_f32_32x32x16_bf16 v[128:143], v[92:95], v[60:63], v[128:143]
    ds_read_b64_tr_b16 v[144:145], v19 offset:24576
    ds_read_b64_tr_b16 v[146:147], v19 offset:25088
    ds_read_b128 v[48:51], v14 offset:24576
    s_waitcnt lgkmcnt(12)
    v_mfma_f32_32x32x16_bf16 v[128:143], v[96:99], v[32:35], v[128:143]
    s_cmp_eq_u32 s12, 0
    s_cbranch_scc1 nofl_39
    v_mov_b32 v30, s42
    v_mov_b32 v31, s43
    s_waitcnt vmcnt(0)
    s_mov_b64 exec, 1
    buffer_store_dwordx2 v[30:31], off, s[56:59], s12 sc1
    s_mov_b64 exec, -1
    s_setprio 0
nofl_39:
    ds_read_b64_tr_b16 v[148:149], v19 offset:26624
    ds_read_b64_tr_b16 v[150:151], v19 offset:27136
    ds_read_b128 v[52:55], v15 offset:24576
    s_waitcnt lgkmcnt(12)
    v_mfma_f32_32x32x16_bf16 v[128:143], v[100:103], v[36:39], v[128:143]
    ds_read_b64_tr_b16 v[152:153], v19 offset:28672
    ds_read_b64_tr_b16 v[154:155], v19 offset:29184
    ds_read_b128 v[56:59], v16 offset:24576
    s_waitcnt lgkmcnt(12)
    v_mfma_f32_32x32x16_bf16 v[128:143], v[104:107], v[40:43], v[128:143]
    ds_read_b64_tr_b16 v[156:157], v19 offset:30720
    ds_read_b64_tr_b16 v[158:159], v19 offset:31232
    ds_read_b128 v[60:63], v17 offset:24576
    s_waitcnt lgkmcnt(12)
    v_mfma_f32_32x32x16_bf16 v[128:143], v[108:111], v[44:47], v[128:143]
    ds_read_b64_tr_b16 v[160:161], v19 offset:32768
    ds_read_b64_tr_b16 v[162:163], v19 offset:33280
    ds_read_b128 v[32:35], v14 offset:32768
    s_waitcnt lgkmcnt(12)
    v_mfma_f32_32x32x16_bf16 v[128:143], v[144:147], v[48:51], v[128:143]
    ds_read_b64_tr_b16 v[164:165], v19 offset:34816
    ds_read_b64_tr_b16 v[166:167], v19 offset:35328
    ds_read_b128 v[36:39], v15 offset:32768
    s_waitcnt lgkmcnt(12)
    v_mfma_f32_32x32x16_bf16 v[128:143], v[148:151], v[52:55], v[128:143]
    ds_read_b64_tr_b16 v[168:169], v19 offset:36864
    ds_read_b64_tr_b16 v[170:171], v19 offset:37376
    ds_read_b128 v[40:43], v16 offset:32768
    s_waitcnt lgkmcnt(12)
    v_mfma_f32_32x32x16_bf16 v[128:143], v[152:155], v[56:59], v[128:143]
    ds_read_b64_tr_b16 v[172:173], v19 offset:38912
    ds_read_b64_tr_b16 v[174:175], v19 offset:39424
    ds_read_b128 v[44:47], v17 offset:32768
    s_waitcnt lgkmcnt(12)
    v_mfma_f32_32x32x16_bf16 v[128:143], v[156:159], v[60:63], v[128:143]
    ds_read_b64_tr_b16 v[224:225], v19 offset:40960
    ds_read_b64_tr_b16 v[226:227], v19 offset:41472
    ds_read_b128 v[48:51], v14 offset:40960
    s_waitcnt lgkmcnt(12)
    v_mfma_f32_32x32x16_bf16 v[128:143], v[160:163], v[32:35], v[128:143]
    ds_read_b64_tr_b16 v[228:229], v19 offset:43008
    ds_read_b64_tr_b16 v[230:231], v19 offset:43520
    ds_read_b128 v[52:55], v15 offset:40960
    s_waitcnt lgkmcnt(12)
    v_mfma_f32_32x32x16_bf16 v[128:143], v[164:167], v[36:39], v[128:143]
    ds_read_b64_tr_b16 v[232:233], v19 offset:45056
    ds_read_b64_tr_b16 v[234:235], v19 offset:45568
    ds_read_b128 v[56:59], v16 offset:40960
    s_waitcnt lgkmcnt(12)
    v_mfma_f32_32x32x16_bf16 v[128:143], v[168:171], v[40:43], v[128:143]
    ds_read_b64_tr_b16 v[236:237], v19 offset:47104
    ds_read_b64_tr_b16 v[238:239], v19 offset:47616
    ds_read_b128 v[60:63], v17 offset:40960
    s_waitcnt lgkmcnt(12)
    v_mfma_f32_32x32x16_bf16 v[128:143], v[172:175], v[44:47], v[128:143]
    ds_read_b64_tr_b16 v[240:241], v19 offset:49152
    ds_read_b64_tr_b16 v[242:243], v19 offset:49664
    ds_read_b128 v[32:35], v14 offset:49152
    s_waitcnt lgkmcnt(12)
    v_mfma_f32_32x32x16_bf16 v[128:143], v[224:227], v[48:51], v[128:143]
    ds_read_b64_tr_b16 v[244:245], v19 offset:51200
    ds_read_b64_tr_b16 v[246:247], v19 offset:51712
    ds_read_b128 v[36:39], v15 offset:49152
    s_waitcnt lgkmcnt(12)
    v_mfma_f32_32x32x16_bf16 v[128:143], v[228:231], v[52:55], v[128:143]
    ds_read_b64_tr_b16 v[120:121], v19 offset:53248
    ds_read_b64_tr_b16 v[122:123], v19 offset:53760
    ds_read_b128 v[40:43], v16 offset:49152
    s_waitcnt lgkmcnt(12)
    v_mfma_f32_32x32x16_bf16 v[128:143], v[232:235], v[56:59], v[128:143]
    ds_read_b64_tr_b16 v[124:125], v19 offset:55296
    ds_read_b64_tr_b16 v[126:127], v19 offset:55808
    ds_read_b128 v[44:47], v17 offset:49152
    s_waitcnt lgkmcnt(12)
    v_mfma_f32_32x32x16_bf16 v[128:143], v[236:239], v[60:63], v[128:143]
    s_waitcnt lgkmcnt(9)
    v_mfma_f32_32x32x16_bf16 v[128:143], v[240:243], v[32:35], v[128:143]
    s_waitcnt lgkmcnt(6)
    v_mfma_f32_32x32x16_bf16 v[128:143], v[244:247], v[36:39], v[128:143]
    s_waitcnt lgkmcnt(3)
    v_mfma_f32_32x32x16_bf16 v[128:143], v[120:123], v[40:43], v[128:143]
    s_waitcnt lgkmcnt(0)
    v_mfma_f32_32x32x16_bf16 v[128:143], v[124:127], v[44:47], v[128:143]
    s_add_u32 s76, s40, 2097152
    s_addc_u32 s77, s41, 0
    s_add_u32 s8, s7, 1
    s_lshl_b32 s78, s8, 16
    s_mov_b32 s79, 0x20000
    v_lshlrev_b32 v5, 7, v1
    v_lshlrev_b32 v25, 6, v2
    s_lshr_b32 s96, s4, 1
    s_and_b32 s96, s96, 4
    s_add_u32 s96, s96, s6
    s_lshl_b32 s96, s96, 13
    s_lshl_b32 s8, s7, 16
    s_add_u32 s96, s96, s8
    s_and_b32 s8, s4, 0x14
    s_cmp_lg_u32 s8, 0
    s_cselect_b32 s96, 1073741824, s96
    s_lshl_b32 s95, s7, 8
    s_lshl_b32 s95, s95, 3
    s_add_u32 s95, s95, 10616832
    v_dot2c_f32_bf16 v23, s82, v64
    v_dot2c_f32_bf16 v23, s82, v65
    v_dot2c_f32_bf16 v23, s82, v66
    v_dot2c_f32_bf16 v23, s82, v67
    v_dot2c_f32_bf16 v23, s82, v68
    v_dot2c_f32_bf16 v23, s82, v69
    v_dot2c_f32_bf16 v23, s82, v70
    v_dot2c_f32_bf16 v23, s82, v71
    v_dot2c_f32_bf16 v23, s82, v72
    v_dot2c_f32_bf16 v23, s82, v73
    v_dot2c_f32_bf16 v23, s82, v74
    v_dot2c_f32_bf16 v23, s82, v75
    v_dot2c_f32_bf16 v23, s82, v76
    v_dot2c_f32_bf16 v23, s82, v77
    v_dot2c_f32_bf16 v23, s82, v78
    v_dot2c_f32_bf16 v23, s82, v79
    v_dot2c_f32_bf16 v23, s82, v80
    v_dot2c_f32_bf16 v23, s82, v81
    v_dot2c_f32_bf16 v23, s82, v82
    v_dot2c_f32_bf16 v23, s82, v83
    v_dot2c_f32_bf16 v23, s82, v84
    v_dot2c_f32_bf16 v23, s82, v85
    v_dot2c_f32_bf16 v23, s82, v86
    v_dot2c_f32_bf16 v23, s82, v87
    v_dot2c_f32_bf16 v23, s82, v88
    v_dot2c_f32_bf16 v23, s82, v89
    v_dot2c_f32_bf16 v23, s82, v90
    v_dot2c_f32_bf16 v23, s82, v91
    v_dot2c_f32_bf16 v23, s82, v92
    v_dot2c_f32_bf16 v23, s82, v93
    v_dot2c_f32_bf16 v23, s82, v94
    v_dot2c_f32_bf16 v23, s82, v95
    v_dot2c_f32_bf16 v23, s82, v96
    v_dot2c_f32_bf16 v23, s82, v97
    v_dot2c_f32_bf16 v23, s82, v98
    v_dot2c_f32_bf16 v23, s82, v99
    v_dot2c_f32_bf16 v23, s82, v100
    v_dot2c_f32_bf16 v23, s82, v101
    v_dot2c_f32_bf16 v23, s82, v102
    v_dot2c_f32_bf16 v23, s82, v103
    v_dot2c_f32_bf16 v23, s82, v104
    v_dot2c_f32_bf16 v23, s82, v105
    v_dot2c_f32_bf16 v23, s82, v106
    v_dot2c_f32_bf16 v23, s82, v107
    v_dot2c_f32_bf16 v23, s82, v108
    v_dot2c_f32_bf16 v23, s82, v109
    v_dot2c_f32_bf16 v23, s82, v110
    v_dot2c_f32_bf16 v23, s82, v111
    v_dot2c_f32_bf16 v23, s82, v144
    v_dot2c_f32_bf16 v23, s82, v145
    v_dot2c_f32_bf16 v23, s82, v146
    v_dot2c_f32_bf16 v23, s82, v147
    v_dot2c_f32_bf16 v23, s82, v148
    v_dot2c_f32_bf16 v23, s82, v149
    v_dot2c_f32_bf16 v23, s82, v150
    v_dot2c_f32_bf16 v23, s82, v151
    v_dot2c_f32_bf16 v23, s82, v152
    v_dot2c_f32_bf16 v23, s82, v153
    v_dot2c_f32_bf16 v23, s82, v154
    v_dot2c_f32_bf16 v23, s82, v155
    v_dot2c_f32_bf16 v23, s82, v156
    v_dot2c_f32_bf16 v23, s82, v157
    v_dot2c_f32_bf16 v23, s82, v158
    v_dot2c_f32_bf16 v23, s82, v159
    v_dot2c_f32_bf16 v23, s82, v160
    v_dot2c_f32_bf16 v23, s82, v161
    v_dot2c_f32_bf16 v23, s82, v162
    v_dot2c_f32_bf16 v23, s82, v163
    v_dot2c_f32_bf16 v23, s82, v164
    v_dot2c_f32_bf16 v23, s82, v165
    v_dot2c_f32_bf16 v23, s82, v166
    v_dot2c_f32_bf16 v23, s82, v167
    v_dot2c_f32_bf16 v23, s82, v168
    v_dot2c_f32_bf16 v23, s82, v169
    v_dot2c_f32_bf16 v23, s82, v170
    v_dot2c_f32_bf16 v23, s82, v171
    v_dot2c_f32_bf16 v23, s82, v172
    v_dot2c_f32_bf16 v23, s82, v173
    v_dot2c_f32_bf16 v23, s82, v174
    v_dot2c_f32_bf16 v23, s82, v175
    v_dot2c_f32_bf16 v23, s82, v224
    v_dot2c_f32_bf16 v23, s82, v225
    v_dot2c_f32_bf16 v23, s82, v226
    v_dot2c_f32_bf16 v23, s82, v227
    v_dot2c_f32_bf16 v23, s82, v228
    v_dot2c_f32_bf16 v23, s82, v229
    v_dot2c_f32_bf16 v23, s82, v230
    v_dot2c_f32_bf16 v23, s82, v231
    v_dot2c_f32_bf16 v23, s82, v232
    v_dot2c_f32_bf16 v23, s82, v233
    v_dot2c_f32_bf16 v23, s82, v234
    v_dot2c_f32_bf16 v23, s82, v235
    v_dot2c_f32_bf16 v23, s82, v236
    v_dot2c_f32_bf16 v23, s82, v237
    v_dot2c_f32_bf16 v23, s82, v238
    v_dot2c_f32_bf16 v23, s82, v239
    v_dot2c_f32_bf16 v23, s82, v240
    v_dot2c_f32_bf16 v23, s82, v241
    v_dot2c_f32_bf16 v23, s82, v242
    v_dot2c_f32_bf16 v23, s82, v243
    v_dot2c_f32_bf16 v23, s82, v244
    v_dot2c_f32_bf16 v23, s82, v245
    v_dot2c_f32_bf16 v23, s82, v246
    v_dot2c_f32_bf16 v23, s82, v247
    v_dot2c_f32_bf16 v23, s82, v120
    v_dot2c_f32_bf16 v23, s82, v121
    v_dot2c_f32_bf16 v23, s82, v122
    v_dot2c_f32_bf16 v23, s82, v123
    v_dot2c_f32_bf16 v23, s82, v124
    v_dot2c_f32_bf16 v23, s82, v125
    v_dot2c_f32_bf16 v23, s82, v126
    v_dot2c_f32_bf16 v23, s82, v127
    s_branch spe_41
spin_40:
    s_sleep 1
spe_41:
    ds_read_b32 v28, v0 offset:12
    s_waitcnt lgkmcnt(0)
    v_readfirstlane_b32 s13, v28
    s_cmp_lt_u32 s13, 8
    s_cbranch_scc1 spin_40
    ds_read_b64 v[116:117], v24
    v_cvt_pk_bf16_f32 v21, v23, v23
    v_and_b32 v21, 0xffff0000, v21
    v_sub_f32 v21, v23, v21
    v_cvt_pk_bf16_f32 v112, v23, v21
    s_waitcnt lgkmcnt(0)
    v_mov_b32 v22, v117
    v_mov_b32 v23, v117
    v_mov_b32 v117, 0
    s_nop 1
    v_mfma_f32_32x32x16_bf16 v[128:143], v[112:115], v[116:119], v[128:143]
    s_lshl_b32 s9, s7, 11
    s_add_u32 s9, s9, 147456
    v_add_u32 v21, s9, v4
    v_mov_b32 v64, 0
    v_mov_b32 v65, 0
    v_mov_b32 v66, 0
    v_mov_b32 v67, 0
    v_mov_b32 v68, 0
    v_mov_b32 v69, 0
    v_mov_b32 v70, 0
    v_mov_b32 v71, 0
    v_mov_b32 v72, 0
    v_mov_b32 v73, 0
    v_mov_b32 v74, 0
    v_mov_b32 v75, 0
    v_pk_mul_f32 v[128:129], v[128:129], v[22:23]
    v_pk_mul_f32 v[130:131], v[130:131], v[22:23]
    v_pk_mul_f32 v[132:133], v[132:133], v[22:23]
    v_pk_mul_f32 v[134:135], v[134:135], v[22:23]
    v_pk_mul_f32 v[136:137], v[136:137], v[22:23]
    v_pk_mul_f32 v[138:139], v[138:139], v[22:23]
    v_pk_mul_f32 v[140:141], v[140:141], v[22:23]
    v_pk_mul_f32 v[142:143], v[142:143], v[22:23]
    v_cvt_pk_bf16_f32 v32, v128, v129
    v_cvt_pk_bf16_f32 v33, v130, v131
    v_cvt_pk_bf16_f32 v34, v132, v133
    v_cvt_pk_bf16_f32 v35, v134, v135
    v_cvt_pk_bf16_f32 v36, v136, v137
    v_cvt_pk_bf16_f32 v37, v138, v139
    v_cvt_pk_bf16_f32 v38, v140, v141
    v_cvt_pk_bf16_f32 v39, v142, v143
    s_mov_b64 exec, s[14:15]
    v_mov_b32 v38, 0
    v_mov_b32 v39, 0
    s_mov_b64 exec, -1
    ds_write_b128 v21, v[32:35]
    ds_write_b128 v21, v[36:39] offset:1024
    s_mov_b64 exec, 1
    ds_add_u32 v0, v29 offset:16
    s_mov_b64 exec, -1
    s_mov_b32 s11, 0
    s_branch spe_48
spin_47:
    s_sleep 1
spe_48:
    ds_read_b32 v28, v0 offset:52
    s_waitcnt lgkmcnt(0)
    v_readfirstlane_b32 s13, v28
    s_cmp_lt_u32 s13, 4
    s_cbranch_scc1 spin_47
    buffer_load_dwordx2 v[30:31], v25, s[56:59], s95 offen sc1
    s_add_u32 s8, s7, 1
    s_and_b32 s8, s8, 3
    s_lshl_b32 s8, s8, 11
    s_add_u32 s8, s8, 147456
    v_add_u32 v17, s8, v4
    s_add_u32 s8, s7, 2
    s_and_b32 s8, s8, 3
    s_lshl_b32 s8, s8, 11
    s_add_u32 s8, s8, 147456
    v_add_u32 v18, s8, v4
    s_add_u32 s8, s7, 3
    s_and_b32 s8, s8, 3
    s_lshl_b32 s8, s8, 11
    s_add_u32 s8, s8, 147456
    v_add_u32 v19, s8, v4
    s_add_u32 s8, s7, 1
    s_and_b32 s8, s8, 3
    s_lshl_b32 s10, s8, 9
    s_add_u32 s10, s10, 155648
    v_lshl_add_u32 v8, v2, 2, s10
    s_mul_i32 s10, s8, 12288
    s_add_u32 s10, s10, 0
    v_add_u32 v12, s10, v4
    s_add_u32 s8, s7, 2
    s_and_b32 s8, s8, 3
    s_lshl_b32 s10, s8, 9
    s_add_u32 s10, s10, 155776
    v_lshl_add_u32 v9, v2, 2, s10
    s_mul_i32 s10, s8, 12288
    s_add_u32 s10, s10, 4096
    v_add_u32 v13, s10, v4
    s_add_u32 s8, s7, 3
    s_and_b32 s8, s8, 3
    s_lshl_b32 s10, s8, 9
    s_add_u32 s10, s10, 155904
    v_lshl_add_u32 v10, v2, 2, s10
    s_mul_i32 s10, s8, 12288
    s_add_u32 s10, s10, 8192
    v_add_u32 v14, s10, v4
    s_add_u32 s8, s7, 4
    s_and_b32 s8, s8, 3
    s_lshl_b32 s10, s8, 9
    s_add_u32 s10, s10, 156032
    v_lshl_add_u32 v11, v2, 2, s10
    s_mul_i32 s10, s8, 12288
    s_add_u32 s10, s10, 0
    v_add_u32 v16, s10, v4
    v_subrev_u32 v15, 384, v11
    s_add_u32 s8, s7, 3
    s_and_b32 s10, s8, 1
    s_lshl_b32 s84, s6, 1
    s_add_u32 s84, s84, s10
    s_lshl_b32 s84, s84, 12
    s_lshl_b32 s10, s5, 16
    s_add_u32 s84, s84, s10
    s_and_b32 s10, s8, 2
    s_lshl_b32 s10, s10, 9
    s_add_u32 s84, s84, s10
    s_add_u32 s84, s84, 7340032
    s_lshl_b32 s85, s5, 3
    s_add_u32 s85, s85, s6
    s_lshl_b32 s85, s85, 2
    s_add_u32 s85, s85, s7
    s_lshl_b32 s85, s85, 6
    s_add_u32 s85, s85, 10813440
    s_mov_b32 s12, 0x71800000
    v_mov_b32 v76, 0
    v_mov_b32 v77, 0
    v_mov_b32 v78, 0
    v_mov_b32 v79, 0
    v_mov_b32 v80, 0
    v_mov_b32 v81, 0
    v_mov_b32 v82, 0
    v_mov_b32 v83, 0
    v_mov_b32 v84, 0
    v_mov_b32 v85, 0
    v_mov_b32 v86, 0
    v_mov_b32 v87, 0
    v_mov_b32 v88, 0
    v_mov_b32 v89, 0
    v_mov_b32 v90, 0
    v_mov_b32 v91, 0
    v_mov_b32 v92, 0
    v_mov_b32 v93, 0
    v_mov_b32 v94, 0
    v_mov_b32 v95, 0
    v_mov_b32 v96, 0
    v_mov_b32 v97, 0
    v_mov_b32 v98, 0
    v_mov_b32 v99, 0
    v_mov_b32 v100, 0
    v_mov_b32 v101, 0
    v_mov_b32 v102, 0
    v_mov_b32 v103, 0
    v_mov_b32 v104, 0
    v_mov_b32 v105, 0
    s_waitcnt vmcnt(0)
    v_cmp_ne_u64 vcc, s[42:43], v[30:31]
    s_cbranch_vccz att_havekv_46
    s_setprio 3
    v_min_u32 v28, 31, v1
    v_lshlrev_b32 v28, 6, v28
    s_mov_b32 s83, 20000
poll_49:
    buffer_load_dwordx2 v[30:31], v28, s[56:59], s95 offen sc1
    s_waitcnt vmcnt(0)
    v_cmp_ne_u64 vcc, s[42:43], v[30:31]
    s_cbranch_vccz polld_50
    s_sub_u32 s83, s83, 1
    s_cmp_lg_u32 s83, 0
    s_cbranch_scc1 poll_49
polld_50:
    s_setprio 0
att_havekv_46:
    s_lshl_b32 s94, s7, 16
    buffer_load_dwordx4 v[176:179], v4, s[76:79], s94 offen offset:0 sc1
    buffer_load_dwordx4 v[180:183], v4, s[76:79], s94 offen offset:1024 sc1
    buffer_load_dwordx4 v[184:187], v4, s[76:79], s94 offen offset:2048 sc1
    buffer_load_dwordx4 v[188:191], v4, s[76:79], s94 offen offset:3072 sc1
    s_add_u32 s94, s94, 4096
    buffer_load_dword v253, v5, s[76:79], s96 offen sc1
    buffer_load_dwordx4 v[192:195], v4, s[76:79], s94 offen offset:0 sc1
    buffer_load_dwordx4 v[196:199], v4, s[76:79], s94 offen offset:1024 sc1
    buffer_load_dwordx4 v[200:203], v4, s[76:79], s94 offen offset:2048 sc1
    buffer_load_dwordx4 v[204:207], v4, s[76:79], s94 offen offset:3072 sc1
    s_add_u32 s94, s94, 4096
    buffer_load_dwordx4 v[208:211], v4, s[76:79], s94 offen offset:0 sc1
    buffer_load_dwordx4 v[212:215], v4, s[76:79], s94 offen offset:1024 sc1
    buffer_load_dwordx4 v[216:219], v4, s[76:79], s94 offen offset:2048 sc1
    buffer_load_dwordx4 v[220:223], v4, s[76:79], s94 offen offset:3072 sc1
    s_add_u32 s94, s94, 4096
    s_branch spe_52
spin_51:
    s_sleep 1
spe_52:
    ds_read_b32 v28, v0 offset:16
    s_waitcnt lgkmcnt(0)
    v_readfirstlane_b32 s13, v28
    s_cmp_lt_u32 s13, 4
    s_cbranch_scc1 spin_51
    ds_read_b128 v[40:43], v17
    ds_read_b128 v[44:47], v17 offset:1024
    ds_read_b128 v[48:51], v18
    ds_read_b128 v[52:55], v18 offset:1024
    ds_read_b128 v[56:59], v19
    ds_read_b128 v[60:63], v19 offset:1024
    v_mov_b32 v106, 0
    v_mov_b32 v107, 0
    v_mov_b32 v108, 0
    v_mov_b32 v109, 0
    v_mov_b32 v110, 0
    v_mov_b32 v111, 0
    v_mov_b32 v112, 0
    v_mov_b32 v113, 0
    v_mov_b32 v114, 0
    v_mov_b32 v115, 0
    v_mov_b32 v116, 0
    v_mov_b32 v117, 0
    v_mov_b32 v118, 0
    v_mov_b32 v119, 0
    v_mov_b32 v120, 0
    v_mov_b32 v121, 0
    v_mov_b32 v122, 0
    v_mov_b32 v123, 0
    v_mov_b32 v124, 0
    v_mov_b32 v125, 0
    v_mov_b32 v126, 0
    v_mov_b32 v127, 0
    s_waitcnt vmcnt(11) lgkmcnt(0)
    v_mfma_f32_32x32x16_bf16 v[128:143], v[176:179], v[32:35], 0
    v_mfma_f32_32x32x16_bf16 v[128:143], v[180:183], v[36:39], v[128:143]
    v_mfma_f32_32x32x16_bf16 v[144:159], v[176:179], v[40:43], 0
    v_mfma_f32_32x32x16_bf16 v[144:159], v[180:183], v[44:47], v[144:159]
    v_mfma_f32_32x32x16_bf16 v[224:239], v[176:179], v[48:51], 0
    v_mfma_f32_32x32x16_bf16 v[224:239], v[180:183], v[52:55], v[224:239]
    v_mfma_f32_32x32x16_bf16 v[160:175], v[176:179], v[56:59], 0
    v_mfma_f32_32x32x16_bf16 v[160:175], v[180:183], v[60:63], v[160:175]
    s_nop 4
    s_mov_b64 exec, s[14:15]
    v_max3_f32 v20, v128, v129, v130
    v_max3_f32 v20, v131, v132, v20
    v_max3_f32 v20, v133, v134, v20
    v_max3_f32 v20, v135, v136, v20
    v_max3_f32 v20, v137, v138, v20
    v_max3_f32 v20, v139, v140, v20
    v_max3_f32 v20, v141, v142, v20
    v_max_f32 v20, v143, v20
    v_cvt_pk_bf16_f32 v38, -v20, 0
    v_lshlrev_b32 v20, 16, v38
    v_max3_f32 v21, v144, v145, v146
    v_max3_f32 v21, v147, v148, v21
    v_max3_f32 v21, v149, v150, v21
    v_max3_f32 v21, v151, v152, v21
    v_max3_f32 v21, v153, v154, v21
    v_max3_f32 v21, v155, v156, v21
    v_max3_f32 v21, v157, v158, v21
    v_max_f32 v21, v159, v21
    v_cvt_pk_bf16_f32 v46, -v21, 0
    v_lshlrev_b32 v21, 16, v46
    v_max3_f32 v22, v224, v225, v226
    v_max3_f32 v22, v227, v228, v22
    v_max3_f32 v22, v229, v230, v22
    v_max3_f32 v22, v231, v232, v22
    v_max3_f32 v22, v233, v234, v22
    v_max3_f32 v22, v235, v236, v22
    v_max3_f32 v22, v237, v238, v22
    v_max_f32 v22, v239, v22
    v_cvt_pk_bf16_f32 v54, -v22, 0
    v_lshlrev_b32 v22, 16, v54
    v_max3_f32 v23, v160, v161, v162
    v_max3_f32 v23, v163, v164, v23
    v_max3_f32 v23, v165, v166, v23
    v_max3_f32 v23, v167, v168, v23
    v_max3_f32 v23, v169, v170, v23
    v_max3_f32 v23, v171, v172, v23
    v_max3_f32 v23, v173, v174, v23
    v_max_f32 v23, v175, v23
    v_cvt_pk_bf16_f32 v62, -v23, 0
    v_lshlrev_b32 v23, 16, v62
att_go_42:
    ds_write_b32 v8, v20
    ds_write_b32 v9, v21
    ds_write_b32 v10, v22
    ds_write_b32 v11, v23
    s_mov_b64 exec, -1
    v_mfma_f32_32x32x16_bf16 v[128:143], v[176:179], v[32:35], 0
    v_mfma_f32_32x32x16_bf16 v[128:143], v[180:183], v[36:39], v[128:143]
    s_add_u32 s8, s94, 4096
    v_add_u32 v7, s8, v4
    v_mov_b32 v232, 0
    v_mov_b32 v233, 0
    v_mov_b32 v234, 0
    v_mov_b32 v235, 0
    v_mov_b32 v236, 0
    v_mov_b32 v237, 0
    v_mov_b32 v238, 0
    v_mov_b32 v239, 0
    v_mov_b32 v168, 0
    v_mov_b32 v169, 0
    v_mov_b32 v170, 0
    v_mov_b32 v171, 0
    v_mov_b32 v172, 0
    v_mov_b32 v173, 0
    v_mov_b32 v174, 0
    v_mov_b32 v175, 0
    v_mov_b32 v158, 0
    v_mov_b32 v159, 0
    s_mov_b32 s9, 3
    s_waitcnt vmcnt(8)
.p2align 6
att_loop_44:
    v_exp_f32 v128, v128
    v_exp_f32 v129, v129
    v_cvt_pk_bf16_f32 v175, v158, v159
    v_mfma_f32_32x32x16_bf16 v[144:159], v[176:179], v[40:43], 0
    v_exp_f32 v130, v130
    v_exp_f32 v131, v131
    v_cvt_pk_bf16_f32 v160, v128, v129
    v_exp_f32 v132, v132
    v_exp_f32 v133, v133
    v_cvt_pk_bf16_f32 v161, v130, v131
    v_mfma_f32_32x32x16_bf16 v[144:159], v[180:183], v[44:47], v[144:159]
    v_exp_f32 v134, v134
    v_exp_f32 v135, v135
    global_load_dwordx4 v[224:227], v7, s[76:77] offset:-4096 sc1
    v_cvt_pk_bf16_f32 v162, v132, v133
    v_exp_f32 v136, v136
    v_exp_f32 v137, v137
    v_cvt_pk_bf16_f32 v163, v134, v135
    v_mfma_f32_32x32x16_bf16 v[112:127], v[232:235], v[168:171], v[112:127]
    v_exp_f32 v138, v138
    v_exp_f32 v139, v139
    v_cvt_pk_bf16_f32 v164, v136, v137
    v_exp_f32 v140, v140
    v_exp_f32 v141, v141
    v_cvt_pk_bf16_f32 v165, v138, v139
    v_mfma_f32_32x32x16_bf16 v[112:127], v[236:239], v[172:175], v[112:127]
    v_exp_f32 v142, v142
    v_exp_f32 v143, v143
    v_cvt_pk_bf16_f32 v166, v140, v141
    v_exp_f32 v144, v144
    v_exp_f32 v145, v145
    v_cvt_pk_bf16_f32 v167, v142, v143
    v_mfma_f32_32x32x16_bf16 v[128:143], v[176:179], v[48:51], 0
    v_exp_f32 v146, v146
    v_exp_f32 v147, v147
    v_cvt_pk_bf16_f32 v168, v144, v145
    v_exp_f32 v148, v148
    v_mfma_f32_32x32x16_bf16 v[128:143], v[180:183], v[52:55], v[128:143]
    v_exp_f32 v149, v149
    v_cvt_pk_bf16_f32 v169, v146, v147
    v_exp_f32 v150, v150
    v_exp_f32 v151, v151
    global_load_dwordx4 v[228:231], v7, s[76:77] offset:-3072 sc1
    v_cvt_pk_bf16_f32 v170, v148, v149
    v_exp_f32 v152, v152
    v_exp_f32 v153, v153
    v_cvt_pk_bf16_f32 v171, v150, v151
    v_mfma_f32_32x32x16_bf16 v[64:79], v[184:187], v[160:163], v[64:79]
    v_exp_f32 v154, v154
    v_exp_f32 v155, v155
    v_cvt_pk_bf16_f32 v172, v152, v153
    v_exp_f32 v156, v156
    v_mfma_f32_32x32x16_bf16 v[64:79], v[188:191], v[164:167], v[64:79]
    v_exp_f32 v157, v157
    v_cvt_pk_bf16_f32 v173, v154, v155
    v_exp_f32 v158, v158
    v_exp_f32 v159, v159
    v_cvt_pk_bf16_f32 v174, v156, v157
    v_exp_f32 v128, v128
    v_exp_f32 v129, v129
    v_cvt_pk_bf16_f32 v175, v158, v159
    v_mfma_f32_32x32x16_bf16 v[144:159], v[176:179], v[56:59], 0
    v_exp_f32 v130, v130
    v_exp_f32 v131, v131
    v_cvt_pk_bf16_f32 v160, v128, v129
    v_exp_f32 v132, v132
    v_mfma_f32_32x32x16_bf16 v[144:159], v[180:183], v[60:63], v[144:159]
    v_exp_f32 v133, v133
    v_cvt_pk_bf16_f32 v161, v130, v131
    v_exp_f32 v134, v134
    v_exp_f32 v135, v135
    global_load_dwordx4 v[232:235], v7, s[76:77] offset:-2048 sc1
    v_cvt_pk_bf16_f32 v162, v132, v133
    v_exp_f32 v136, v136
    v_exp_f32 v137, v137
    v_cvt_pk_bf16_f32 v163, v134, v135
    v_mfma_f32_32x32x16_bf16 v[80:95], v[184:187], v[168:171], v[80:95]
    v_exp_f32 v138, v138
    v_exp_f32 v139, v139
    v_cvt_pk_bf16_f32 v164, v136, v137
    v_exp_f32 v140, v140
    v_mfma_f32_32x32x16_bf16 v[80:95], v[188:191], v[172:175], v[80:95]
    v_exp_f32 v141, v141
    v_cvt_pk_bf16_f32 v165, v138, v139
    v_exp_f32 v142, v142
    v_exp_f32 v143, v143
    v_cvt_pk_bf16_f32 v166, v140, v141
    v_exp_f32 v144, v144
    s_waitcnt vmcnt(7)
    v_exp_f32 v145, v145
    v_cvt_pk_bf16_f32 v167, v142, v143
    v_mfma_f32_32x32x16_bf16 v[128:143], v[192:195], v[32:35], 0
    v_exp_f32 v146, v146
    v_exp_f32 v147, v147
    v_cvt_pk_bf16_f32 v168, v144, v145
    v_exp_f32 v148, v148
    v_mfma_f32_32x32x16_bf16 v[128:143], v[196:199], v[36:39], v[128:143]
    v_exp_f32 v149, v149
    v_cvt_pk_bf16_f32 v169, v146, v147
    v_exp_f32 v150, v150
    v_exp_f32 v151, v151
    global_load_dwordx4 v[236:239], v7, s[76:77] offset:-1024 sc1
    v_cvt_pk_bf16_f32 v170, v148, v149
    v_exp_f32 v152, v152
    v_exp_f32 v153, v153
    v_cvt_pk_bf16_f32 v171, v150, v151
    v_mfma_f32_32x32x16_bf16 v[96:111], v[184:187], v[160:163], v[96:111]
    v_exp_f32 v154, v154
    v_exp_f32 v155, v155
    v_cvt_pk_bf16_f32 v172, v152, v153
    v_exp_f32 v156, v156
    v_mfma_f32_32x32x16_bf16 v[96:111], v[188:191], v[164:167], v[96:111]
    v_exp_f32 v157, v157
    v_cvt_pk_bf16_f32 v173, v154, v155
    v_exp_f32 v158, v158
    v_exp_f32 v159, v159
    v_cvt_pk_bf16_f32 v174, v156, v157
    v_exp_f32 v128, v128
    v_exp_f32 v129, v129
    v_cvt_pk_bf16_f32 v175, v158, v159
    v_mfma_f32_32x32x16_bf16 v[144:159], v[192:195], v[40:43], 0
    v_exp_f32 v130, v130
    v_exp_f32 v131, v131
    v_cvt_pk_bf16_f32 v160, v128, v129
    v_exp_f32 v132, v132
    v_exp_f32 v133, v133
    v_cvt_pk_bf16_f32 v161, v130, v131
    v_mfma_f32_32x32x16_bf16 v[144:159], v[196:199], v[44:47], v[144:159]
    v_exp_f32 v134, v134
    v_exp_f32 v135, v135
    global_load_dwordx4 v[176:179], v7, s[76:77] offset:0 sc1
    v_cvt_pk_bf16_f32 v162, v132, v133
    v_exp_f32 v136, v136
    v_exp_f32 v137, v137
    v_cvt_pk_bf16_f32 v163, v134, v135
    v_mfma_f32_32x32x16_bf16 v[112:127], v[184:187], v[168:171], v[112:127]
    v_exp_f32 v138, v138
    v_exp_f32 v139, v139
    v_cvt_pk_bf16_f32 v164, v136, v137
    v_exp_f32 v140, v140
    v_exp_f32 v141, v141
    v_cvt_pk_bf16_f32 v165, v138, v139
    v_mfma_f32_32x32x16_bf16 v[112:127], v[188:191], v[172:175], v[112:127]
    v_exp_f32 v142, v142
    v_exp_f32 v143, v143
    v_cvt_pk_bf16_f32 v166, v140, v141
    v_exp_f32 v144, v144
    v_exp_f32 v145, v145
    v_cvt_pk_bf16_f32 v167, v142, v143
    v_mfma_f32_32x32x16_bf16 v[128:143], v[192:195], v[48:51], 0
    v_exp_f32 v146, v146
    v_exp_f32 v147, v147
    v_cvt_pk_bf16_f32 v168, v144, v145
    v_exp_f32 v148, v148
    v_mfma_f32_32x32x16_bf16 v[128:143], v[196:199], v[52:55], v[128:143]
    v_exp_f32 v149, v149
    v_cvt_pk_bf16_f32 v169, v146, v147
    v_exp_f32 v150, v150
    v_exp_f32 v151, v151
    global_load_dwordx4 v[180:183], v7, s[76:77] offset:1024 sc1
    v_cvt_pk_bf16_f32 v170, v148, v149
    v_exp_f32 v152, v152
    v_exp_f32 v153, v153
    v_cvt_pk_bf16_f32 v171, v150, v151
    v_mfma_f32_32x32x16_bf16 v[64:79], v[200:203], v[160:163], v[64:79]
    v_exp_f32 v154, v154
    v_exp_f32 v155, v155
    v_cvt_pk_bf16_f32 v172, v152, v153
    v_exp_f32 v156, v156
    v_mfma_f32_32x32x16_bf16 v[64:79], v[204:207], v[164:167], v[64:79]
    v_exp_f32 v157, v157
    v_cvt_pk_bf16_f32 v173, v154, v155
    v_exp_f32 v158, v158
    v_exp_f32 v159, v159
    v_cvt_pk_bf16_f32 v174, v156, v157
    v_exp_f32 v128, v128
    v_exp_f32 v129, v129
    v_cvt_pk_bf16_f32 v175, v158, v159
    v_mfma_f32_32x32x16_bf16 v[144:159], v[192:195], v[56:59], 0
    v_exp_f32 v130, v130
    v_exp_f32 v131, v131
    v_cvt_pk_bf16_f32 v160, v128, v129
    v_exp_f32 v132, v132
    v_mfma_f32_32x32x16_bf16 v[144:159], v[196:199], v[60:63], v[144:159]
    v_exp_f32 v133, v133
    v_cvt_pk_bf16_f32 v161, v130, v131
    v_exp_f32 v134, v134
    v_exp_f32 v135, v135
    global_load_dwordx4 v[184:187], v7, s[76:77] offset:2048 sc1
    v_cvt_pk_bf16_f32 v162, v132, v133
    v_exp_f32 v136, v136
    v_exp_f32 v137, v137
    v_cvt_pk_bf16_f32 v163, v134, v135
    v_mfma_f32_32x32x16_bf16 v[80:95], v[200:203], v[168:171], v[80:95]
    v_exp_f32 v138, v138
    v_exp_f32 v139, v139
    v_cvt_pk_bf16_f32 v164, v136, v137
    v_exp_f32 v140, v140
    v_mfma_f32_32x32x16_bf16 v[80:95], v[204:207], v[172:175], v[80:95]
    v_exp_f32 v141, v141
    v_cvt_pk_bf16_f32 v165, v138, v139
    v_exp_f32 v142, v142
    v_exp_f32 v143, v143
    v_cvt_pk_bf16_f32 v166, v140, v141
    v_exp_f32 v144, v144
    s_waitcnt vmcnt(7)
    v_exp_f32 v145, v145
    v_cvt_pk_bf16_f32 v167, v142, v143
    v_mfma_f32_32x32x16_bf16 v[128:143], v[208:211], v[32:35], 0
    v_exp_f32 v146, v146
    v_exp_f32 v147, v147
    v_cvt_pk_bf16_f32 v168, v144, v145
    v_exp_f32 v148, v148
    v_mfma_f32_32x32x16_bf16 v[128:143], v[212:215], v[36:39], v[128:143]
    v_exp_f32 v149, v149
    v_cvt_pk_bf16_f32 v169, v146, v147
    v_exp_f32 v150, v150
    v_exp_f32 v151, v151
    global_load_dwordx4 v[188:191], v7, s[76:77] offset:3072 sc1
    v_cvt_pk_bf16_f32 v170, v148, v149
    v_exp_f32 v152, v152
    v_exp_f32 v153, v153
    v_add_u32 v7, 0x2000, v7
    v_cvt_pk_bf16_f32 v171, v150, v151
    v_mfma_f32_32x32x16_bf16 v[96:111], v[200:203], v[160:163], v[96:111]
    v_exp_f32 v154, v154
    v_exp_f32 v155, v155
    v_cvt_pk_bf16_f32 v172, v152, v153
    v_exp_f32 v156, v156
    v_mfma_f32_32x32x16_bf16 v[96:111], v[204:207], v[164:167], v[96:111]
    v_exp_f32 v157, v157
    v_cvt_pk_bf16_f32 v173, v154, v155
    v_exp_f32 v158, v158
    v_exp_f32 v159, v159
    v_cvt_pk_bf16_f32 v174, v156, v157
    v_exp_f32 v128, v128
    v_exp_f32 v129, v129
    v_cvt_pk_bf16_f32 v175, v158, v159
    v_mfma_f32_32x32x16_bf16 v[144:159], v[208:211], v[40:43], 0
    v_exp_f32 v130, v130
    v_exp_f32 v131, v131
    v_cvt_pk_bf16_f32 v160, v128, v129
    v_exp_f32 v132, v132
    v_exp_f32 v133, v133
    v_cvt_pk_bf16_f32 v161, v130, v131
    v_mfma_f32_32x32x16_bf16 v[144:159], v[212:215], v[44:47], v[144:159]
    v_exp_f32 v134, v134
    v_exp_f32 v135, v135
    global_load_dwordx4 v[192:195], v7, s[76:77] offset:-4096 sc1
    v_cvt_pk_bf16_f32 v162, v132, v133
    v_exp_f32 v136, v136
    v_exp_f32 v137, v137
    v_cvt_pk_bf16_f32 v163, v134, v135
    v_mfma_f32_32x32x16_bf16 v[112:127], v[200:203], v[168:171], v[112:127]
    v_exp_f32 v138, v138
    v_exp_f32 v139, v139
    v_cvt_pk_bf16_f32 v164, v136, v137
    v_exp_f32 v140, v140
    v_exp_f32 v141, v141
    v_cvt_pk_bf16_f32 v165, v138, v139
    v_mfma_f32_32x32x16_bf16 v[112:127], v[204:207], v[172:175], v[112:127]
    v_exp_f32 v142, v142
    v_exp_f32 v143, v143
    v_cvt_pk_bf16_f32 v166, v140, v141
    v_exp_f32 v144, v144
    v_exp_f32 v145, v145
    v_cvt_pk_bf16_f32 v167, v142, v143
    v_mfma_f32_32x32x16_bf16 v[128:143], v[208:211], v[48:51], 0
    v_exp_f32 v146, v146
    v_exp_f32 v147, v147
    v_cvt_pk_bf16_f32 v168, v144, v145
    v_exp_f32 v148, v148
    v_mfma_f32_32x32x16_bf16 v[128:143], v[212:215], v[52:55], v[128:143]
    v_exp_f32 v149, v149
    v_cvt_pk_bf16_f32 v169, v146, v147
    v_exp_f32 v150, v150
    v_exp_f32 v151, v151
    global_load_dwordx4 v[196:199], v7, s[76:77] offset:-3072 sc1
    v_cvt_pk_bf16_f32 v170, v148, v149
    v_exp_f32 v152, v152
    v_exp_f32 v153, v153
    v_cvt_pk_bf16_f32 v171, v150, v151
    v_mfma_f32_32x32x16_bf16 v[64:79], v[216:219], v[160:163], v[64:79]
    v_exp_f32 v154, v154
    v_exp_f32 v155, v155
    v_cvt_pk_bf16_f32 v172, v152, v153
    v_exp_f32 v156, v156
    v_mfma_f32_32x32x16_bf16 v[64:79], v[220:223], v[164:167], v[64:79]
    v_exp_f32 v157, v157
    v_cvt_pk_bf16_f32 v173, v154, v155
    v_exp_f32 v158, v158
    v_exp_f32 v159, v159
    v_cvt_pk_bf16_f32 v174, v156, v157
    v_exp_f32 v128, v128
    v_exp_f32 v129, v129
    v_cvt_pk_bf16_f32 v175, v158, v159
    v_mfma_f32_32x32x16_bf16 v[144:159], v[208:211], v[56:59], 0
    v_exp_f32 v130, v130
    v_exp_f32 v131, v131
    v_cvt_pk_bf16_f32 v160, v128, v129
    v_exp_f32 v132, v132
    v_mfma_f32_32x32x16_bf16 v[144:159], v[212:215], v[60:63], v[144:159]
    v_exp_f32 v133, v133
    v_cvt_pk_bf16_f32 v161, v130, v131
    v_exp_f32 v134, v134
    v_exp_f32 v135, v135
    global_load_dwordx4 v[200:203], v7, s[76:77] offset:-2048 sc1
    v_cvt_pk_bf16_f32 v162, v132, v133
    v_exp_f32 v136, v136
    v_exp_f32 v137, v137
    v_cvt_pk_bf16_f32 v163, v134, v135
    v_mfma_f32_32x32x16_bf16 v[80:95], v[216:219], v[168:171], v[80:95]
    v_exp_f32 v138, v138
    v_exp_f32 v139, v139
    v_cvt_pk_bf16_f32 v164, v136, v137
    v_exp_f32 v140, v140
    v_mfma_f32_32x32x16_bf16 v[80:95], v[220:223], v[172:175], v[80:95]
    v_exp_f32 v141, v141
    v_cvt_pk_bf16_f32 v165, v138, v139
    v_exp_f32 v142, v142
    v_exp_f32 v143, v143
    v_cvt_pk_bf16_f32 v166, v140, v141
    v_exp_f32 v144, v144
    s_waitcnt vmcnt(7)
    v_exp_f32 v145, v145
    v_cvt_pk_bf16_f32 v167, v142, v143
    v_mfma_f32_32x32x16_bf16 v[128:143], v[224:227], v[32:35], 0
    v_exp_f32 v146, v146
    v_exp_f32 v147, v147
    v_cvt_pk_bf16_f32 v168, v144, v145
    v_exp_f32 v148, v148
    v_mfma_f32_32x32x16_bf16 v[128:143], v[228:231], v[36:39], v[128:143]
    v_exp_f32 v149, v149
    v_cvt_pk_bf16_f32 v169, v146, v147
    v_exp_f32 v150, v150
    v_exp_f32 v151, v151
    global_load_dwordx4 v[204:207], v7, s[76:77] offset:-1024 sc1
    v_cvt_pk_bf16_f32 v170, v148, v149
    v_exp_f32 v152, v152
    v_exp_f32 v153, v153
    v_cvt_pk_bf16_f32 v171, v150, v151
    v_mfma_f32_32x32x16_bf16 v[96:111], v[216:219], v[160:163], v[96:111]
    v_exp_f32 v154, v154
    v_exp_f32 v155, v155
    v_cvt_pk_bf16_f32 v172, v152, v153
    v_exp_f32 v156, v156
    v_mfma_f32_32x32x16_bf16 v[96:111], v[220:223], v[164:167], v[96:111]
    v_exp_f32 v157, v157
    v_cvt_pk_bf16_f32 v173, v154, v155
    v_exp_f32 v158, v158
    v_exp_f32 v159, v159
    v_cvt_pk_bf16_f32 v174, v156, v157
    v_exp_f32 v128, v128
    v_exp_f32 v129, v129
    v_cvt_pk_bf16_f32 v175, v158, v159
    v_mfma_f32_32x32x16_bf16 v[144:159], v[224:227], v[40:43], 0
    v_exp_f32 v130, v130
    v_exp_f32 v131, v131
    v_cvt_pk_bf16_f32 v160, v128, v129
    v_exp_f32 v132, v132
    v_exp_f32 v133, v133
    v_cvt_pk_bf16_f32 v161, v130, v131
    v_mfma_f32_32x32x16_bf16 v[144:159], v[228:231], v[44:47], v[144:159]
    v_exp_f32 v134, v134
    v_exp_f32 v135, v135
    global_load_dwordx4 v[208:211], v7, s[76:77] offset:0 sc1
    v_cvt_pk_bf16_f32 v162, v132, v133
    v_exp_f32 v136, v136
    v_exp_f32 v137, v137
    v_cvt_pk_bf16_f32 v163, v134, v135
    v_mfma_f32_32x32x16_bf16 v[112:127], v[216:219], v[168:171], v[112:127]
    v_exp_f32 v138, v138
    v_exp_f32 v139, v139
    v_cvt_pk_bf16_f32 v164, v136, v137
    v_exp_f32 v140, v140
    v_exp_f32 v141, v141
    v_cvt_pk_bf16_f32 v165, v138, v139
    v_mfma_f32_32x32x16_bf16 v[112:127], v[220:223], v[172:175], v[112:127]
    v_exp_f32 v142, v142
    v_exp_f32 v143, v143
    v_cvt_pk_bf16_f32 v166, v140, v141
    v_exp_f32 v144, v144
    v_exp_f32 v145, v145
    v_cvt_pk_bf16_f32 v167, v142, v143
    v_mfma_f32_32x32x16_bf16 v[128:143], v[224:227], v[48:51], 0
    v_exp_f32 v146, v146
    v_exp_f32 v147, v147
    v_cvt_pk_bf16_f32 v168, v144, v145
    v_exp_f32 v148, v148
    v_mfma_f32_32x32x16_bf16 v[128:143], v[228:231], v[52:55], v[128:143]
    v_exp_f32 v149, v149
    v_cvt_pk_bf16_f32 v169, v146, v147
    v_exp_f32 v150, v150
    v_exp_f32 v151, v151
    global_load_dwordx4 v[212:215], v7, s[76:77] offset:1024 sc1
    v_cvt_pk_bf16_f32 v170, v148, v149
    v_exp_f32 v152, v152
    v_exp_f32 v153, v153
    v_cvt_pk_bf16_f32 v171, v150, v151
    v_mfma_f32_32x32x16_bf16 v[64:79], v[232:235], v[160:163], v[64:79]
    v_exp_f32 v154, v154
    v_exp_f32 v155, v155
    v_cvt_pk_bf16_f32 v172, v152, v153
    v_exp_f32 v156, v156
    v_mfma_f32_32x32x16_bf16 v[64:79], v[236:239], v[164:167], v[64:79]
    v_exp_f32 v157, v157
    v_cvt_pk_bf16_f32 v173, v154, v155
    v_exp_f32 v158, v158
    v_exp_f32 v159, v159
    v_cvt_pk_bf16_f32 v174, v156, v157
    v_exp_f32 v128, v128
    v_exp_f32 v129, v129
    v_cvt_pk_bf16_f32 v175, v158, v159
    v_mfma_f32_32x32x16_bf16 v[144:159], v[224:227], v[56:59], 0
    v_exp_f32 v130, v130
    v_exp_f32 v131, v131
    v_cvt_pk_bf16_f32 v160, v128, v129
    v_exp_f32 v132, v132
    v_mfma_f32_32x32x16_bf16 v[144:159], v[228:231], v[60:63], v[144:159]
    v_exp_f32 v133, v133
    v_cvt_pk_bf16_f32 v161, v130, v131
    v_exp_f32 v134, v134
    v_exp_f32 v135, v135
    global_load_dwordx4 v[216:219], v7, s[76:77] offset:2048 sc1
    v_cvt_pk_bf16_f32 v162, v132, v133
    v_exp_f32 v136, v136
    v_exp_f32 v137, v137
    v_cvt_pk_bf16_f32 v163, v134, v135
    v_mfma_f32_32x32x16_bf16 v[80:95], v[232:235], v[168:171], v[80:95]
    v_exp_f32 v138, v138
    v_exp_f32 v139, v139
    v_cvt_pk_bf16_f32 v164, v136, v137
    v_exp_f32 v140, v140
    v_mfma_f32_32x32x16_bf16 v[80:95], v[236:239], v[172:175], v[80:95]
    v_exp_f32 v141, v141
    v_cvt_pk_bf16_f32 v165, v138, v139
    v_exp_f32 v142, v142
    v_exp_f32 v143, v143
    v_cvt_pk_bf16_f32 v166, v140, v141
    v_exp_f32 v144, v144
    s_waitcnt vmcnt(7)
    v_exp_f32 v145, v145
    v_cvt_pk_bf16_f32 v167, v142, v143
    v_mfma_f32_32x32x16_bf16 v[128:143], v[176:179], v[32:35], 0
    v_exp_f32 v146, v146
    v_exp_f32 v147, v147
    v_cvt_pk_bf16_f32 v168, v144, v145
    v_exp_f32 v148, v148
    v_mfma_f32_32x32x16_bf16 v[128:143], v[180:183], v[36:39], v[128:143]
    v_exp_f32 v149, v149
    v_cvt_pk_bf16_f32 v169, v146, v147
    v_exp_f32 v150, v150
    v_exp_f32 v151, v151
    global_load_dwordx4 v[220:223], v7, s[76:77] offset:3072 sc1
    v_cvt_pk_bf16_f32 v170, v148, v149
    v_exp_f32 v152, v152
    v_exp_f32 v153, v153
    v_add_u32 v7, 0x2000, v7
    v_cvt_pk_bf16_f32 v171, v150, v151
    v_mfma_f32_32x32x16_bf16 v[96:111], v[232:235], v[160:163], v[96:111]
    v_exp_f32 v154, v154
    v_exp_f32 v155, v155
    s_sub_u32 s9, s9, 1
    v_cvt_pk_bf16_f32 v172, v152, v153
    v_exp_f32 v156, v156
    v_mfma_f32_32x32x16_bf16 v[96:111], v[236:239], v[164:167], v[96:111]
    v_exp_f32 v157, v157
    v_cvt_pk_bf16_f32 v173, v154, v155
    v_exp_f32 v158, v158
    s_cmp_lg_u32 s9, 0
    v_exp_f32 v159, v159
    v_cvt_pk_bf16_f32 v174, v156, v157
    s_cbranch_scc1 att_loop_44
    v_exp_f32 v128, v128
    v_exp_f32 v129, v129
    v_cvt_pk_bf16_f32 v175, v158, v159
    v_mfma_f32_32x32x16_bf16 v[144:159], v[176:179], v[40:43], 0
    v_exp_f32 v130, v130
    v_exp_f32 v131, v131
    v_cvt_pk_bf16_f32 v160, v128, v129
    v_exp_f32 v132, v132
    v_mfma_f32_32x32x16_bf16 v[144:159], v[180:183], v[44:47], v[144:159]
    v_exp_f32 v133, v133
    v_cvt_pk_bf16_f32 v161, v130, v131
    v_exp_f32 v134, v134
    v_exp_f32 v135, v135
    global_load_dwordx4 v[224:227], v7, s[76:77] offset:-4096 sc1
    v_cvt_pk_bf16_f32 v162, v132, v133
    v_exp_f32 v136, v136
    v_exp_f32 v137, v137
    v_cvt_pk_bf16_f32 v163, v134, v135
    v_mfma_f32_32x32x16_bf16 v[112:127], v[232:235], v[168:171], v[112:127]
    v_exp_f32 v138, v138
    v_exp_f32 v139, v139
    v_cvt_pk_bf16_f32 v164, v136, v137
    v_exp_f32 v140, v140
    v_mfma_f32_32x32x16_bf16 v[112:127], v[236:239], v[172:175], v[112:127]
    v_exp_f32 v141, v141
    v_cvt_pk_bf16_f32 v165, v138, v139
    v_exp_f32 v142, v142
    v_exp_f32 v143, v143
    v_cvt_pk_bf16_f32 v166, v140, v141
    v_exp_f32 v144, v144
    v_exp_f32 v145, v145
    v_cvt_pk_bf16_f32 v167, v142, v143
    v_mfma_f32_32x32x16_bf16 v[128:143], v[176:179], v[48:51], 0
    v_exp_f32 v146, v146
    v_exp_f32 v147, v147
    v_cvt_pk_bf16_f32 v168, v144, v145
    v_exp_f32 v148, v148
    v_mfma_f32_32x32x16_bf16 v[128:143], v[180:183], v[52:55], v[128:143]
    v_exp_f32 v149, v149
    v_cvt_pk_bf16_f32 v169, v146, v147
    v_exp_f32 v150, v150
    v_exp_f32 v151, v151
    global_load_dwordx4 v[228:231], v7, s[76:77] offset:-3072 sc1
    v_cvt_pk_bf16_f32 v170, v148, v149
    v_exp_f32 v152, v152
    v_exp_f32 v153, v153
    v_cvt_pk_bf16_f32 v171, v150, v151
    v_mfma_f32_32x32x16_bf16 v[64:79], v[184:187], v[160:163], v[64:79]
    v_exp_f32 v154, v154
    v_exp_f32 v155, v155
    v_cvt_pk_bf16_f32 v172, v152, v153
    v_exp_f32 v156, v156
    v_mfma_f32_32x32x16_bf16 v[64:79], v[188:191], v[164:167], v[64:79]
    v_exp_f32 v157, v157
    v_cvt_pk_bf16_f32 v173, v154, v155
    v_exp_f32 v158, v158
    v_exp_f32 v159, v159
    v_cvt_pk_bf16_f32 v174, v156, v157
    v_exp_f32 v128, v128
    v_exp_f32 v129, v129
    v_cvt_pk_bf16_f32 v175, v158, v159
    v_mfma_f32_32x32x16_bf16 v[144:159], v[176:179], v[56:59], 0
    v_exp_f32 v130, v130
    v_exp_f32 v131, v131
    v_cvt_pk_bf16_f32 v160, v128, v129
    v_exp_f32 v132, v132
    v_mfma_f32_32x32x16_bf16 v[144:159], v[180:183], v[60:63], v[144:159]
    v_exp_f32 v133, v133
    v_cvt_pk_bf16_f32 v161, v130, v131
    v_exp_f32 v134, v134
    v_exp_f32 v135, v135
    global_load_dwordx4 v[232:235], v7, s[76:77] offset:-2048 sc1
    v_cvt_pk_bf16_f32 v162, v132, v133
    v_exp_f32 v136, v136
    v_exp_f32 v137, v137
    v_cvt_pk_bf16_f32 v163, v134, v135
    v_mfma_f32_32x32x16_bf16 v[80:95], v[184:187], v[168:171], v[80:95]
    v_exp_f32 v138, v138
    v_exp_f32 v139, v139
    v_cvt_pk_bf16_f32 v164, v136, v137
    v_exp_f32 v140, v140
    v_mfma_f32_32x32x16_bf16 v[80:95], v[188:191], v[172:175], v[80:95]
    v_exp_f32 v141, v141
    v_cvt_pk_bf16_f32 v165, v138, v139
    v_exp_f32 v142, v142
    v_exp_f32 v143, v143
    v_cvt_pk_bf16_f32 v166, v140, v141
    v_exp_f32 v144, v144
    s_waitcnt vmcnt(7)
    v_exp_f32 v145, v145
    v_cvt_pk_bf16_f32 v167, v142, v143
    v_mfma_f32_32x32x16_bf16 v[128:143], v[192:195], v[32:35], 0
    v_exp_f32 v146, v146
    v_exp_f32 v147, v147
    v_cvt_pk_bf16_f32 v168, v144, v145
    v_exp_f32 v148, v148
    v_mfma_f32_32x32x16_bf16 v[128:143], v[196:199], v[36:39], v[128:143]
    v_exp_f32 v149, v149
    v_cvt_pk_bf16_f32 v169, v146, v147
    v_exp_f32 v150, v150
    v_exp_f32 v151, v151
    global_load_dwordx4 v[236:239], v7, s[76:77] offset:-1024 sc1
    v_cvt_pk_bf16_f32 v170, v148, v149
    v_exp_f32 v152, v152
    v_exp_f32 v153, v153
    v_cvt_pk_bf16_f32 v171, v150, v151
    v_mfma_f32_32x32x16_bf16 v[96:111], v[184:187], v[160:163], v[96:111]
    v_exp_f32 v154, v154
    v_exp_f32 v155, v155
    v_cvt_pk_bf16_f32 v172, v152, v153
    v_exp_f32 v156, v156
    v_mfma_f32_32x32x16_bf16 v[96:111], v[188:191], v[164:167], v[96:111]
    v_exp_f32 v157, v157
    v_cvt_pk_bf16_f32 v173, v154, v155
    v_exp_f32 v158, v158
    v_exp_f32 v159, v159
    v_cvt_pk_bf16_f32 v174, v156, v157
    v_exp_f32 v128, v128
    v_exp_f32 v129, v129
    v_cvt_pk_bf16_f32 v175, v158, v159
    v_mfma_f32_32x32x16_bf16 v[144:159], v[192:195], v[40:43], 0
    v_exp_f32 v130, v130
    v_exp_f32 v131, v131
    v_cvt_pk_bf16_f32 v160, v128, v129
    v_exp_f32 v132, v132
    v_mfma_f32_32x32x16_bf16 v[144:159], v[196:199], v[44:47], v[144:159]
    v_exp_f32 v133, v133
    v_cvt_pk_bf16_f32 v161, v130, v131
    v_exp_f32 v134, v134
    v_exp_f32 v135, v135
    v_cvt_pk_bf16_f32 v162, v132, v133
    v_exp_f32 v136, v136
    v_exp_f32 v137, v137
    v_cvt_pk_bf16_f32 v163, v134, v135
    v_mfma_f32_32x32x16_bf16 v[112:127], v[184:187], v[168:171], v[112:127]
    v_exp_f32 v138, v138
    v_exp_f32 v139, v139
    v_cvt_pk_bf16_f32 v164, v136, v137
    v_exp_f32 v140, v140
    v_mfma_f32_32x32x16_bf16 v[112:127], v[188:191], v[172:175], v[112:127]
    v_exp_f32 v141, v141
    v_cvt_pk_bf16_f32 v165, v138, v139
    v_exp_f32 v142, v142
    v_exp_f32 v143, v143
    v_cvt_pk_bf16_f32 v166, v140, v141
    v_exp_f32 v144, v144
    v_exp_f32 v145, v145
    v_cvt_pk_bf16_f32 v167, v142, v143
    v_mfma_f32_32x32x16_bf16 v[128:143], v[192:195], v[48:51], 0
    v_exp_f32 v146, v146
    v_exp_f32 v147, v147
    v_cvt_pk_bf16_f32 v168, v144, v145
    v_exp_f32 v148, v148
    v_mfma_f32_32x32x16_bf16 v[128:143], v[196:199], v[52:55], v[128:143]
    v_exp_f32 v149, v149
    v_cvt_pk_bf16_f32 v169, v146, v147
    v_exp_f32 v150, v150
    v_exp_f32 v151, v151
    v_cvt_pk_bf16_f32 v170, v148, v149
    v_exp_f32 v152, v152
    v_exp_f32 v153, v153
    v_cvt_pk_bf16_f32 v171, v150, v151
    v_mfma_f32_32x32x16_bf16 v[64:79], v[200:203], v[160:163], v[64:79]
    v_exp_f32 v154, v154
    v_exp_f32 v155, v155
    v_cvt_pk_bf16_f32 v172, v152, v153
    v_exp_f32 v156, v156
    v_mfma_f32_32x32x16_bf16 v[64:79], v[204:207], v[164:167], v[64:79]
    v_exp_f32 v157, v157
    v_cvt_pk_bf16_f32 v173, v154, v155
    v_exp_f32 v158, v158
    v_exp_f32 v159, v159
    v_cvt_pk_bf16_f32 v174, v156, v157
    v_exp_f32 v128, v128
    v_exp_f32 v129, v129
    v_cvt_pk_bf16_f32 v175, v158, v159
    v_mfma_f32_32x32x16_bf16 v[144:159], v[192:195], v[56:59], 0
    v_exp_f32 v130, v130
    v_exp_f32 v131, v131
    v_cvt_pk_bf16_f32 v160, v128, v129
    v_exp_f32 v132, v132
    v_mfma_f32_32x32x16_bf16 v[144:159], v[196:199], v[60:63], v[144:159]
    v_exp_f32 v133, v133
    v_cvt_pk_bf16_f32 v161, v130, v131
    v_exp_f32 v134, v134
    v_exp_f32 v135, v135
    v_cvt_pk_bf16_f32 v162, v132, v133
    v_exp_f32 v136, v136
    v_exp_f32 v137, v137
    v_cvt_pk_bf16_f32 v163, v134, v135
    v_mfma_f32_32x32x16_bf16 v[80:95], v[200:203], v[168:171], v[80:95]
    v_exp_f32 v138, v138
    v_exp_f32 v139, v139
    v_cvt_pk_bf16_f32 v164, v136, v137
    v_exp_f32 v140, v140
    v_mfma_f32_32x32x16_bf16 v[80:95], v[204:207], v[172:175], v[80:95]
    v_exp_f32 v141, v141
    v_cvt_pk_bf16_f32 v165, v138, v139
    v_exp_f32 v142, v142
    v_exp_f32 v143, v143
    v_cvt_pk_bf16_f32 v166, v140, v141
    v_exp_f32 v144, v144
    s_waitcnt vmcnt(4)
    v_exp_f32 v145, v145
    v_cvt_pk_bf16_f32 v167, v142, v143
    v_mfma_f32_32x32x16_bf16 v[128:143], v[208:211], v[32:35], 0
    v_exp_f32 v146, v146
    v_exp_f32 v147, v147
    v_cvt_pk_bf16_f32 v168, v144, v145
    v_exp_f32 v148, v148
    v_mfma_f32_32x32x16_bf16 v[128:143], v[212:215], v[36:39], v[128:143]
    v_exp_f32 v149, v149
    v_cvt_pk_bf16_f32 v169, v146, v147
    v_exp_f32 v150, v150
    v_exp_f32 v151, v151
    v_cvt_pk_bf16_f32 v170, v148, v149
    v_exp_f32 v152, v152
    v_exp_f32 v153, v153
    v_cvt_pk_bf16_f32 v171, v150, v151
    v_mfma_f32_32x32x16_bf16 v[96:111], v[200:203], v[160:163], v[96:111]
    v_exp_f32 v154, v154
    v_exp_f32 v155, v155
    v_cvt_pk_bf16_f32 v172, v152, v153
    v_exp_f32 v156, v156
    v_mfma_f32_32x32x16_bf16 v[96:111], v[204:207], v[164:167], v[96:111]
    v_exp_f32 v157, v157
    v_cvt_pk_bf16_f32 v173, v154, v155
    v_exp_f32 v158, v158
    v_exp_f32 v159, v159
    v_cvt_pk_bf16_f32 v174, v156, v157
    v_exp_f32 v128, v128
    v_exp_f32 v129, v129
    v_cvt_pk_bf16_f32 v175, v158, v159
    v_mfma_f32_32x32x16_bf16 v[144:159], v[208:211], v[40:43], 0
    v_exp_f32 v130, v130
    v_exp_f32 v131, v131
    v_cvt_pk_bf16_f32 v160, v128, v129
    v_exp_f32 v132, v132
    v_mfma_f32_32x32x16_bf16 v[144:159], v[212:215], v[44:47], v[144:159]
    v_exp_f32 v133, v133
    v_cvt_pk_bf16_f32 v161, v130, v131
    v_exp_f32 v134, v134
    v_exp_f32 v135, v135
    v_cvt_pk_bf16_f32 v162, v132, v133
    v_exp_f32 v136, v136
    v_exp_f32 v137, v137
    v_cvt_pk_bf16_f32 v163, v134, v135
    v_mfma_f32_32x32x16_bf16 v[112:127], v[200:203], v[168:171], v[112:127]
    v_exp_f32 v138, v138
    v_exp_f32 v139, v139
    v_cvt_pk_bf16_f32 v164, v136, v137
    v_exp_f32 v140, v140
    v_mfma_f32_32x32x16_bf16 v[112:127], v[204:207], v[172:175], v[112:127]
    v_exp_f32 v141, v141
    v_cvt_pk_bf16_f32 v165, v138, v139
    v_exp_f32 v142, v142
    v_exp_f32 v143, v143
    v_cvt_pk_bf16_f32 v166, v140, v141
    v_exp_f32 v144, v144
    v_exp_f32 v145, v145
    v_cvt_pk_bf16_f32 v167, v142, v143
    v_mfma_f32_32x32x16_bf16 v[128:143], v[208:211], v[48:51], 0
    v_exp_f32 v146, v146
    v_exp_f32 v147, v147
    v_cvt_pk_bf16_f32 v168, v144, v145
    v_exp_f32 v148, v148
    v_mfma_f32_32x32x16_bf16 v[128:143], v[212:215], v[52:55], v[128:143]
    v_exp_f32 v149, v149
    v_cvt_pk_bf16_f32 v169, v146, v147
    v_exp_f32 v150, v150
    v_exp_f32 v151, v151
    v_cvt_pk_bf16_f32 v170, v148, v149
    v_exp_f32 v152, v152
    v_exp_f32 v153, v153
    v_cvt_pk_bf16_f32 v171, v150, v151
    v_mfma_f32_32x32x16_bf16 v[64:79], v[216:219], v[160:163], v[64:79]
    v_exp_f32 v154, v154
    v_exp_f32 v155, v155
    v_cvt_pk_bf16_f32 v172, v152, v153
    v_exp_f32 v156, v156
    v_mfma_f32_32x32x16_bf16 v[64:79], v[220:223], v[164:167], v[64:79]
    v_exp_f32 v157, v157
    v_cvt_pk_bf16_f32 v173, v154, v155
    v_exp_f32 v158, v158
    v_exp_f32 v159, v159
    v_cvt_pk_bf16_f32 v174, v156, v157
    v_exp_f32 v128, v128
    v_exp_f32 v129, v129
    v_cvt_pk_bf16_f32 v175, v158, v159
    v_mfma_f32_32x32x16_bf16 v[144:159], v[208:211], v[56:59], 0
    v_exp_f32 v130, v130
    v_exp_f32 v131, v131
    v_cvt_pk_bf16_f32 v160, v128, v129
    v_exp_f32 v132, v132
    v_mfma_f32_32x32x16_bf16 v[144:159], v[212:215], v[60:63], v[144:159]
    v_exp_f32 v133, v133
    v_cvt_pk_bf16_f32 v161, v130, v131
    v_exp_f32 v134, v134
    v_exp_f32 v135, v135
    v_cvt_pk_bf16_f32 v162, v132, v133
    v_exp_f32 v136, v136
    v_exp_f32 v137, v137
    v_cvt_pk_bf16_f32 v163, v134, v135
    v_mfma_f32_32x32x16_bf16 v[80:95], v[216:219], v[168:171], v[80:95]
    v_exp_f32 v138, v138
    v_exp_f32 v139, v139
    v_cvt_pk_bf16_f32 v164, v136, v137
    v_exp_f32 v140, v140
    v_mfma_f32_32x32x16_bf16 v[80:95], v[220:223], v[172:175], v[80:95]
    v_exp_f32 v141, v141
    v_cvt_pk_bf16_f32 v165, v138, v139
    v_exp_f32 v142, v142
    v_exp_f32 v143, v143
    v_cvt_pk_bf16_f32 v166, v140, v141
    v_exp_f32 v144, v144
    s_waitcnt vmcnt(0)
    v_exp_f32 v145, v145
    v_cvt_pk_bf16_f32 v167, v142, v143
    v_mfma_f32_32x32x16_bf16 v[128:143], v[224:227], v[32:35], 0
    v_exp_f32 v146, v146
    v_exp_f32 v147, v147
    v_cvt_pk_bf16_f32 v168, v144, v145
    v_exp_f32 v148, v148
    v_mfma_f32_32x32x16_bf16 v[128:143], v[228:231], v[36:39], v[128:143]
    v_exp_f32 v149, v149
    v_cvt_pk_bf16_f32 v169, v146, v147
    v_exp_f32 v150, v150
    v_exp_f32 v151, v151
    v_cvt_pk_bf16_f32 v170, v148, v149
    v_exp_f32 v152, v152
    v_exp_f32 v153, v153
    v_cvt_pk_bf16_f32 v171, v150, v151
    v_mfma_f32_32x32x16_bf16 v[96:111], v[216:219], v[160:163], v[96:111]
    v_exp_f32 v154, v154
    v_exp_f32 v155, v155
    v_cvt_pk_bf16_f32 v172, v152, v153
    v_exp_f32 v156, v156
    v_mfma_f32_32x32x16_bf16 v[96:111], v[220:223], v[164:167], v[96:111]
    v_exp_f32 v157, v157
    v_cvt_pk_bf16_f32 v173, v154, v155
    v_exp_f32 v158, v158
    v_exp_f32 v159, v159
    v_cvt_pk_bf16_f32 v174, v156, v157
    v_exp_f32 v128, v128
    v_exp_f32 v129, v129
    v_cvt_pk_bf16_f32 v175, v158, v159
    v_mfma_f32_32x32x16_bf16 v[144:159], v[224:227], v[40:43], 0
    v_exp_f32 v130, v130
    v_exp_f32 v131, v131
    v_cvt_pk_bf16_f32 v160, v128, v129
    v_exp_f32 v132, v132
    v_mfma_f32_32x32x16_bf16 v[144:159], v[228:231], v[44:47], v[144:159]
    v_exp_f32 v133, v133
    v_cvt_pk_bf16_f32 v161, v130, v131
    v_exp_f32 v134, v134
    v_exp_f32 v135, v135
    v_cvt_pk_bf16_f32 v162, v132, v133
    v_exp_f32 v136, v136
    v_exp_f32 v137, v137
    v_cvt_pk_bf16_f32 v163, v134, v135
    v_mfma_f32_32x32x16_bf16 v[112:127], v[216:219], v[168:171], v[112:127]
    v_exp_f32 v138, v138
    v_exp_f32 v139, v139
    v_cvt_pk_bf16_f32 v164, v136, v137
    v_exp_f32 v140, v140
    v_mfma_f32_32x32x16_bf16 v[112:127], v[220:223], v[172:175], v[112:127]
    v_exp_f32 v141, v141
    v_cvt_pk_bf16_f32 v165, v138, v139
    v_exp_f32 v142, v142
    v_exp_f32 v143, v143
    v_cvt_pk_bf16_f32 v166, v140, v141
    v_exp_f32 v144, v144
    v_exp_f32 v145, v145
    v_cvt_pk_bf16_f32 v167, v142, v143
    v_mfma_f32_32x32x16_bf16 v[128:143], v[224:227], v[48:51], 0
    v_exp_f32 v146, v146
    v_exp_f32 v147, v147
    v_cvt_pk_bf16_f32 v168, v144, v145
    v_exp_f32 v148, v148
    v_mfma_f32_32x32x16_bf16 v[128:143], v[228:231], v[52:55], v[128:143]
    v_exp_f32 v149, v149
    v_cvt_pk_bf16_f32 v169, v146, v147
    v_exp_f32 v150, v150
    v_exp_f32 v151, v151
    v_cvt_pk_bf16_f32 v170, v148, v149
    v_exp_f32 v152, v152
    v_exp_f32 v153, v153
    v_cvt_pk_bf16_f32 v171, v150, v151
    v_mfma_f32_32x32x16_bf16 v[64:79], v[232:235], v[160:163], v[64:79]
    v_exp_f32 v154, v154
    v_exp_f32 v155, v155
    v_cvt_pk_bf16_f32 v172, v152, v153
    v_exp_f32 v156, v156
    v_mfma_f32_32x32x16_bf16 v[64:79], v[236:239], v[164:167], v[64:79]
    v_exp_f32 v157, v157
    v_cvt_pk_bf16_f32 v173, v154, v155
    v_exp_f32 v158, v158
    v_exp_f32 v159, v159
    v_cvt_pk_bf16_f32 v174, v156, v157
    s_branch spe_54
spin_53:
    s_sleep 1
spe_54:
    ds_read_b32 v28, v0 offset:28
    s_waitcnt lgkmcnt(0)
    v_readfirstlane_b32 s13, v28
    s_cmp_lt_u32 s13, 4
    s_cbranch_scc1 spin_53
    v_exp_f32 v128, v128
    v_exp_f32 v129, v129
    v_cvt_pk_bf16_f32 v175, v158, v159
    v_mfma_f32_32x32x16_bf16 v[144:159], v[224:227], v[56:59], 0
    v_exp_f32 v130, v130
    v_exp_f32 v131, v131
    v_cvt_pk_bf16_f32 v160, v128, v129
    v_exp_f32 v132, v132
    v_mfma_f32_32x32x16_bf16 v[144:159], v[228:231], v[60:63], v[144:159]
    v_exp_f32 v133, v133
    v_cvt_pk_bf16_f32 v161, v130, v131
    v_exp_f32 v134, v134
    ds_write_b128 v12, v[64:67] offset:0
    v_exp_f32 v135, v135
    v_cvt_pk_bf16_f32 v162, v132, v133
    v_exp_f32 v136, v136
    ds_write_b128 v12, v[68:71] offset:1024
    v_exp_f32 v137, v137
    v_cvt_pk_bf16_f32 v163, v134, v135
    v_mfma_f32_32x32x16_bf16 v[80:95], v[232:235], v[168:171], v[80:95]
    v_exp_f32 v138, v138
    v_exp_f32 v139, v139
    ds_write_b128 v12, v[72:75] offset:2048
    v_cvt_pk_bf16_f32 v164, v136, v137
    v_exp_f32 v140, v140
    v_mfma_f32_32x32x16_bf16 v[80:95], v[236:239], v[172:175], v[80:95]
    v_exp_f32 v141, v141
    v_cvt_pk_bf16_f32 v165, v138, v139
    v_exp_f32 v142, v142
    ds_write_b128 v12, v[76:79] offset:3072
    v_exp_f32 v143, v143
    v_cvt_pk_bf16_f32 v166, v140, v141
    v_exp_f32 v144, v144
    v_exp_f32 v145, v145
    v_cvt_pk_bf16_f32 v167, v142, v143
    v_mfma_f32_32x32x16_bf16 v[96:111], v[232:235], v[160:163], v[96:111]
    v_exp_f32 v146, v146
    v_exp_f32 v147, v147
    v_cvt_pk_bf16_f32 v168, v144, v145
    v_exp_f32 v148, v148
    v_mfma_f32_32x32x16_bf16 v[96:111], v[236:239], v[164:167], v[96:111]
    v_exp_f32 v149, v149
    ds_write_b128 v13, v[80:83] offset:0
    v_cvt_pk_bf16_f32 v169, v146, v147
    v_exp_f32 v150, v150
    ds_write_b128 v13, v[84:87] offset:1024
    v_exp_f32 v151, v151
    v_cvt_pk_bf16_f32 v170, v148, v149
    v_exp_f32 v152, v152
    ds_write_b128 v13, v[88:91] offset:2048
    v_exp_f32 v153, v153
    v_cvt_pk_bf16_f32 v171, v150, v151
    v_exp_f32 v154, v154
    ds_write_b128 v13, v[92:95] offset:3072
    v_exp_f32 v155, v155
    v_cvt_pk_bf16_f32 v172, v152, v153
    v_exp_f32 v156, v156
    v_exp_f32 v157, v157
    ds_write_b128 v14, v[96:99] offset:0
    v_cvt_pk_bf16_f32 v173, v154, v155
    v_exp_f32 v158, v158
    ds_write_b128 v14, v[100:103] offset:1024
    v_exp_f32 v159, v159
    v_cvt_pk_bf16_f32 v174, v156, v157
    v_cvt_pk_bf16_f32 v175, v158, v159
    ds_write_b128 v14, v[104:107] offset:2048
    ds_write_b128 v14, v[108:111] offset:3072
    v_mfma_f32_32x32x16_bf16 v[112:127], v[232:235], v[168:171], v[112:127]
    v_mfma_f32_32x32x16_bf16 v[112:127], v[236:239], v[172:175], v[112:127]
    v_add_f32 v17, v76, v92
    v_add_f32 v17, v17, v108
    v_min3_f32 v18, v76, v92, v108
    s_mov_b32 s8, 0x21800000
    s_nop 7
    v_add_f32 v17, v17, v124
    v_min_f32 v18, v18, v124
    v_cmp_nlt_f32_e64 vcc, v17, s12
    v_cmp_ngt_f32_e64 s[86:87], v18, s8
    s_or_b64 vcc, vcc, s[86:87]
    s_and_b64 vcc, vcc, s[14:15]
    s_cbranch_scc0 att_ok_45
    s_cmp_lg_u32 s11, 0
    s_cbranch_scc1 att_ok_45
    s_mov_b32 s11, 1
    s_waitcnt lgkmcnt(0)
    s_mov_b64 exec, s[14:15]
    v_mov_b32 v38, 0
    v_mov_b32 v39, 0
    v_mov_b32 v46, 0
    v_mov_b32 v47, 0
    v_mov_b32 v54, 0
    v_mov_b32 v55, 0
    v_mov_b32 v62, 0
    v_mov_b32 v63, 0
    s_mov_b64 exec, -1
    s_lshl_b32 s94, s7, 16
    s_mov_b32 s9, 16
    v_mov_b32 v64, 0
    v_mov_b32 v65, 0
    v_mov_b32 v66, 0
    v_mov_b32 v67, 0
    v_mov_b32 v68, 0
    v_mov_b32 v69, 0
    v_mov_b32 v70, 0
    v_mov_b32 v71, 0
    v_mov_b32 v72, 0
    v_mov_b32 v73, 0
    v_mov_b32 v74, 0
    v_mov_b32 v75, 0
    v_mov_b32 v76, 0
    v_mov_b32 v77, 0
    v_mov_b32 v78, 0
    v_mov_b32 v79, 0
    v_mov_b32 v80, 0
    v_mov_b32 v81, 0
    v_mov_b32 v82, 0
    v_mov_b32 v83, 0
    v_mov_b32 v84, 0
    v_mov_b32 v85, 0
    v_mov_b32 v86, 0
    v_mov_b32 v87, 0
    v_mov_b32 v88, 0
    v_mov_b32 v89, 0
    v_mov_b32 v90, 0
    v_mov_b32 v91, 0
    v_mov_b32 v92, 0
    v_mov_b32 v93, 0
    v_mov_b32 v94, 0
    v_mov_b32 v95, 0
    v_mov_b32 v96, 0
    v_mov_b32 v97, 0
    v_mov_b32 v98, 0
    v_mov_b32 v99, 0
    v_mov_b32 v100, 0
    v_mov_b32 v101, 0
    v_mov_b32 v102, 0
    v_mov_b32 v103, 0
    v_mov_b32 v104, 0
    v_mov_b32 v105, 0
    v_mov_b32 v106, 0
    v_mov_b32 v107, 0
    v_mov_b32 v108, 0
    v_mov_b32 v109, 0
    v_mov_b32 v110, 0
    v_mov_b32 v111, 0
    v_mov_b32 v112, 0
    v_mov_b32 v113, 0
    v_mov_b32 v114, 0
    v_mov_b32 v115, 0
    v_mov_b32 v116, 0
    v_mov_b32 v117, 0
    v_mov_b32 v118, 0
    v_mov_b32 v119, 0
    v_mov_b32 v120, 0
    v_mov_b32 v121, 0
    v_mov_b32 v122, 0
    v_mov_b32 v123, 0
    v_mov_b32 v124, 0
    v_mov_b32 v125, 0
    v_mov_b32 v126, 0
    v_mov_b32 v127, 0
    v_mov_b32 v20, 0xff800000
    v_mov_b32 v21, 0xff800000
    v_mov_b32 v22, 0xff800000
    v_mov_b32 v23, 0xff800000
att_mloop_43:
    buffer_load_dwordx4 v[176:179], v4, s[76:79], s94 offen sc1
    buffer_load_dwordx4 v[180:183], v4, s[76:79], s94 offen offset:1024 sc1
    s_add_u32 s94, s94, 4096
    s_waitcnt vmcnt(0)
    v_mfma_f32_32x32x16_bf16 v[128:143], v[176:179], v[32:35], 0
    v_mfma_f32_32x32x16_bf16 v[128:143], v[180:183], v[36:39], v[128:143]
    v_mfma_f32_32x32x16_bf16 v[144:159], v[176:179], v[40:43], 0
    v_mfma_f32_32x32x16_bf16 v[144:159], v[180:183], v[44:47], v[144:159]
    v_mfma_f32_32x32x16_bf16 v[224:239], v[176:179], v[48:51], 0
    v_mfma_f32_32x32x16_bf16 v[224:239], v[180:183], v[52:55], v[224:239]
    v_mfma_f32_32x32x16_bf16 v[160:175], v[176:179], v[56:59], 0
    v_mfma_f32_32x32x16_bf16 v[160:175], v[180:183], v[60:63], v[160:175]
    s_nop 11
    v_max3_f32 v20, v128, v129, v20
    v_max3_f32 v20, v130, v131, v20
    v_max3_f32 v20, v132, v133, v20
    v_max3_f32 v20, v134, v135, v20
    v_max3_f32 v20, v136, v137, v20
    v_max3_f32 v20, v138, v139, v20
    v_max3_f32 v20, v140, v141, v20
    v_max3_f32 v20, v142, v143, v20
    v_max3_f32 v21, v144, v145, v21
    v_max3_f32 v21, v146, v147, v21
    v_max3_f32 v21, v148, v149, v21
    v_max3_f32 v21, v150, v151, v21
    v_max3_f32 v21, v152, v153, v21
    v_max3_f32 v21, v154, v155, v21
    v_max3_f32 v21, v156, v157, v21
    v_max3_f32 v21, v158, v159, v21
    v_max3_f32 v22, v224, v225, v22
    v_max3_f32 v22, v226, v227, v22
    v_max3_f32 v22, v228, v229, v22
    v_max3_f32 v22, v230, v231, v22
    v_max3_f32 v22, v232, v233, v22
    v_max3_f32 v22, v234, v235, v22
    v_max3_f32 v22, v236, v237, v22
    v_max3_f32 v22, v238, v239, v22
    v_max3_f32 v23, v160, v161, v23
    v_max3_f32 v23, v162, v163, v23
    v_max3_f32 v23, v164, v165, v23
    v_max3_f32 v23, v166, v167, v23
    v_max3_f32 v23, v168, v169, v23
    v_max3_f32 v23, v170, v171, v23
    v_max3_f32 v23, v172, v173, v23
    v_max3_f32 v23, v174, v175, v23
    s_sub_u32 s9, s9, 1
    s_cmp_lg_u32 s9, 0
    s_cbranch_scc1 att_mloop_43
    s_lshl_b32 s94, s7, 16
    buffer_load_dwordx4 v[176:179], v4, s[76:79], s94 offen offset:0 sc1
    buffer_load_dwordx4 v[180:183], v4, s[76:79], s94 offen offset:1024 sc1
    buffer_load_dwordx4 v[184:187], v4, s[76:79], s94 offen offset:2048 sc1
    buffer_load_dwordx4 v[188:191], v4, s[76:79], s94 offen offset:3072 sc1
    s_add_u32 s94, s94, 4096
    buffer_load_dword v253, v5, s[76:79], s96 offen sc1
    buffer_load_dwordx4 v[192:195], v4, s[76:79], s94 offen offset:0 sc1
    buffer_load_dwordx4 v[196:199], v4, s[76:79], s94 offen offset:1024 sc1
    buffer_load_dwordx4 v[200:203], v4, s[76:79], s94 offen offset:2048 sc1
    buffer_load_dwordx4 v[204:207], v4, s[76:79], s94 offen offset:3072 sc1
    s_add_u32 s94, s94, 4096
    buffer_load_dwordx4 v[208:211], v4, s[76:79], s94 offen offset:0 sc1
    buffer_load_dwordx4 v[212:215], v4, s[76:79], s94 offen offset:1024 sc1
    buffer_load_dwordx4 v[216:219], v4, s[76:79], s94 offen offset:2048 sc1
    buffer_load_dwordx4 v[220:223], v4, s[76:79], s94 offen offset:3072 sc1
    s_add_u32 s94, s94, 4096
    v_mov_b32 v128, v20
    v_mov_b32 v129, v21
    v_mov_b32 v130, v22
    v_mov_b32 v131, v23
    s_nop 1
    v_permlane32_swap_b32 v128, v20
    v_permlane32_swap_b32 v129, v21
    v_permlane32_swap_b32 v130, v22
    v_permlane32_swap_b32 v131, v23
    v_max_f32 v20, v128, v20
    v_max_f32 v21, v129, v21
    v_max_f32 v22, v130, v22
    v_max_f32 v23, v131, v23
    s_mov_b64 exec, s[14:15]
    v_sub_f32 v20, 0, v20
    v_cvt_pk_bf16_f32 v17, v20, 0
    v_lshlrev_b32 v18, 16, v17
    v_sub_f32 v18, v20, v18
    v_cvt_pk_bf16_f32 v19, v18, 0
    v_lshl_or_b32 v38, v19, 16, v17
    v_lshlrev_b32 v19, 16, v19
    v_sub_f32 v18, v18, v19
    v_cvt_pk_bf16_f32 v39, v18, 0
    v_sub_f32 v21, 0, v21
    v_cvt_pk_bf16_f32 v17, v21, 0
    v_lshlrev_b32 v18, 16, v17
    v_sub_f32 v18, v21, v18
    v_cvt_pk_bf16_f32 v19, v18, 0
    v_lshl_or_b32 v46, v19, 16, v17
    v_lshlrev_b32 v19, 16, v19
    v_sub_f32 v18, v18, v19
    v_cvt_pk_bf16_f32 v47, v18, 0
    v_sub_f32 v22, 0, v22
    v_cvt_pk_bf16_f32 v17, v22, 0
    v_lshlrev_b32 v18, 16, v17
    v_sub_f32 v18, v22, v18
    v_cvt_pk_bf16_f32 v19, v18, 0
    v_lshl_or_b32 v54, v19, 16, v17
    v_lshlrev_b32 v19, 16, v19
    v_sub_f32 v18, v18, v19
    v_cvt_pk_bf16_f32 v55, v18, 0
    v_sub_f32 v23, 0, v23
    v_cvt_pk_bf16_f32 v17, v23, 0
    v_lshlrev_b32 v18, 16, v17
    v_sub_f32 v18, v23, v18
    v_cvt_pk_bf16_f32 v19, v18, 0
    v_lshl_or_b32 v62, v19, 16, v17
    v_lshlrev_b32 v19, 16, v19
    v_sub_f32 v18, v18, v19
    v_cvt_pk_bf16_f32 v63, v18, 0
    s_waitcnt vmcnt(11)
    s_branch att_go_42
att_ok_45:
    s_mov_b64 exec, 1
    ds_add_u32 v0, v29 offset:32
    s_mov_b64 exec, -1
    s_branch spe_56
spin_55:
    s_sleep 1
spe_56:
    ds_read_b32 v28, v0 offset:32
    s_waitcnt lgkmcnt(0)
    v_readfirstlane_b32 s13, v28
    s_cmp_lt_u32 s13, 4
    s_cbranch_scc1 spin_55
    ds_read_b32 v20, v15 offset:0
    ds_read_b32 v21, v15 offset:128
    ds_read_b32 v22, v15 offset:256
    ds_read_b32 v23, v15 offset:384
    ds_read_b128 v[64:67], v16 offset:0
    ds_read_b128 v[68:71], v16 offset:1024
    ds_read_b128 v[72:75], v16 offset:2048
    ds_read_b128 v[76:79], v16 offset:3072
    ds_read_b128 v[80:83], v16 offset:4096
    ds_read_b128 v[84:87], v16 offset:5120
    ds_read_b128 v[88:91], v16 offset:6144
    ds_read_b128 v[92:95], v16 offset:7168
    ds_read_b128 v[96:99], v16 offset:8192
    ds_read_b128 v[100:103], v16 offset:9216
    ds_read_b128 v[104:107], v16 offset:10240
    s_waitcnt lgkmcnt(11)
    ds_read_b128 v[108:111], v16 offset:11264
    v_min3_f32 v17, v20, v21, v22
    v_min_f32 v17, v17, v23
    v_sub_f32 v23, v17, v23
    v_sub_f32 v20, v17, v20
    v_sub_f32 v21, v17, v21
    v_sub_f32 v22, v17, v22
    v_exp_f32 v23, v23
    v_exp_f32 v20, v20
    v_exp_f32 v21, v21
    v_exp_f32 v22, v22
    v_mul_f32 v112, v23, v112
    v_mul_f32 v113, v23, v113
    v_mul_f32 v114, v23, v114
    v_mul_f32 v115, v23, v115
    v_mul_f32 v116, v23, v116
    v_mul_f32 v117, v23, v117
    v_mul_f32 v118, v23, v118
    v_mul_f32 v119, v23, v119
    v_mul_f32 v120, v23, v120
    v_mul_f32 v121, v23, v121
    v_mul_f32 v122, v23, v122
    v_mul_f32 v123, v23, v123
    v_mul_f32 v124, v23, v124
    v_mul_f32 v125, v23, v125
    v_mul_f32 v126, v23, v126
    v_mul_f32 v127, v23, v127
    s_waitcnt lgkmcnt(8)
    v_fmac_f32 v112, v20, v64
    v_fmac_f32 v113, v20, v65
    v_fmac_f32 v114, v20, v66
    v_fmac_f32 v115, v20, v67
    v_fmac_f32 v116, v20, v68
    v_fmac_f32 v117, v20, v69
    v_fmac_f32 v118, v20, v70
    v_fmac_f32 v119, v20, v71
    v_fmac_f32 v120, v20, v72
    v_fmac_f32 v121, v20, v73
    v_fmac_f32 v122, v20, v74
    v_fmac_f32 v123, v20, v75
    v_fmac_f32 v124, v20, v76
    v_fmac_f32 v125, v20, v77
    v_fmac_f32 v126, v20, v78
    v_fmac_f32 v127, v20, v79
    s_waitcnt lgkmcnt(4)
    v_fmac_f32 v112, v21, v80
    v_fmac_f32 v113, v21, v81
    v_fmac_f32 v114, v21, v82
    v_fmac_f32 v115, v21, v83
    v_fmac_f32 v116, v21, v84
    v_fmac_f32 v117, v21, v85
    v_fmac_f32 v118, v21, v86
    v_fmac_f32 v119, v21, v87
    v_fmac_f32 v120, v21, v88
    v_fmac_f32 v121, v21, v89
    v_fmac_f32 v122, v21, v90
    v_fmac_f32 v123, v21, v91
    v_fmac_f32 v124, v21, v92
    v_fmac_f32 v125, v21, v93
    v_fmac_f32 v126, v21, v94
    v_fmac_f32 v127, v21, v95
    s_waitcnt lgkmcnt(0)
    v_fmac_f32 v124, v22, v108
    v_mov_b32 v17, v124
    v_mov_b32 v18, v124
    v_fmac_f32 v112, v22, v96
    v_fmac_f32 v113, v22, v97
    v_permlane32_swap_b32 v17, v18
    v_fmac_f32 v114, v22, v98
    v_rcp_f32 v18, v18
    v_fmac_f32 v115, v22, v99
    v_fmac_f32 v116, v22, v100
    v_fmac_f32 v117, v22, v101
    v_fmac_f32 v118, v22, v102
    v_fmac_f32 v119, v22, v103
    v_fmac_f32 v120, v22, v104
    v_fmac_f32 v121, v22, v105
    v_fmac_f32 v122, v22, v106
    v_fmac_f32 v123, v22, v107
    v_fmac_f32 v125, v22, v109
    v_fmac_f32 v126, v22, v110
    v_fmac_f32 v127, v22, v111
nocomb:
    v_mul_f32 v112, v18, v112
    v_mul_f32 v113, v18, v113
    v_mul_f32 v114, v18, v114
    v_mul_f32 v115, v18, v115
    v_mul_f32 v116, v18, v116
    v_mul_f32 v117, v18, v117
    v_mul_f32 v118, v18, v118
    v_mul_f32 v119, v18, v119
    v_cvt_pk_bf16_f32 v64, v112, v113
    v_cvt_pk_bf16_f32 v65, v114, v115
    v_cvt_pk_bf16_f32 v66, v116, v117
    v_cvt_pk_bf16_f32 v67, v118, v119
    buffer_store_dwordx4 v[64:67], v4, s[56:59], s84 offen offset:0 sc1
    v_mul_f32 v120, v18, v120
    v_mul_f32 v121, v18, v121
    v_mul_f32 v122, v18, v122
    v_mul_f32 v123, v18, v123
    v_mul_f32 v124, v18, v124
    v_mul_f32 v125, v18, v125
    v_mul_f32 v126, v18, v126
    v_mul_f32 v127, v18, v127
    v_cvt_pk_bf16_f32 v68, v120, v121
    v_cvt_pk_bf16_f32 v69, v122, v123
    v_cvt_pk_bf16_f32 v70, v124, v125
    v_cvt_pk_bf16_f32 v71, v126, v127
    s_mov_b64 exec, s[14:15]
    v_mov_b32 v70, 0
    v_mov_b32 v71, 0
    s_mov_b64 exec, -1
    buffer_store_dwordx4 v[68:71], v4, s[56:59], s84 offen offset:2048 sc1
    v_mov_b32 v30, s42
    v_mov_b32 v31, s43
    s_waitcnt vmcnt(0)
    s_mov_b64 exec, 1
    buffer_store_dwordx2 v[30:31], off, s[56:59], s85 sc1
    s_mov_b64 exec, -1
    s_branch fin
p1g:
    s_sub_u32 s84, s7, 4
    s_mov_b32 s13, 11010048
    s_waitcnt lgkmcnt(0)
    s_load_dwordx2 s[42:43], s[40:41], s13
    s_mov_b32 s44, s16
    s_mov_b32 s45, s17
    s_mov_b32 s46, 1835008
    s_mov_b32 s47, 0x20000
    s_mov_b32 s56, s40
    s_mov_b32 s57, s41
    s_mov_b32 s58, 16777216
    s_mov_b32 s59, 0x20000
    v_min_u32 v14, 6, v6
    v_mul_u32_u24 v246, 3584, v5
    v_lshl_add_u32 v246, v14, 7, v246
    s_lshl_b32 s9, s80, 6
    s_lshr_b32 s10, s4, 3
    s_lshl_b32 s10, s10, 1
    s_add_u32 s9, s9, s10
    s_and_b32 s10, s6, 1
    s_add_u32 s9, s9, s10
    s_sub_u32 s9, s9, 1
    s_mul_i32 s99, s9, 28672
    s_lshr_b32 s10, s3, 1
    s_mul_i32 s10, s10, 896
    s_add_u32 s99, s99, s10
    s_mov_b32 s60, s28
    s_mov_b32 s61, s29
    s_mov_b32 s62, 7340032
    s_mov_b32 s63, 0x20000
    s_cmp_ge_u32 s6, 4
    s_cbranch_scc1 gh_57
    s_barrier
    s_mov_b32 s48, s18
    s_mov_b32 s49, s19
    s_mov_b32 s50, 401408
    s_mov_b32 s51, 0x20000
    s_xor_b32 s27, s78, 4096
    s_mul_i32 s8, s79, 57344
    s_add_u32 s26, s77, 28672
    s_sub_u32 s26, s26, s8
    s_mul_i32 s38, s80, 114688
    s_mul_i32 s8, s6, 112
    s_add_u32 s38, s38, s8
    s_lshl_b32 s39, s80, 14
    s_add_u32 m0, s27, 0
    s_add_u32 s8, s26, 0
    buffer_load_dwordx4 v11, s[44:47], s8 offen lds
    s_add_u32 m0, s27, 1024
    s_add_u32 s8, s26, 7168
    buffer_load_dwordx4 v12, s[44:47], s8 offen lds
    s_add_u32 m0, s27, 2048
    s_add_u32 s8, s26, 14336
    buffer_load_dwordx4 v11, s[44:47], s8 offen lds
    s_add_u32 m0, s27, 3072
    s_add_u32 s8, s26, 21504
    buffer_load_dwordx4 v12, s[44:47], s8 offen lds
    s_cmp_eq_u32 s76, 1
    s_cbranch_scc1 rd1_59
    s_add_u32 m0, s27, 8192
    s_add_u32 s8, s26, 128
    buffer_load_dwordx4 v11, s[44:47], s8 offen lds
    s_add_u32 m0, s27, 9216
    s_add_u32 s8, s26, 7296
    buffer_load_dwordx4 v12, s[44:47], s8 offen lds
    s_add_u32 m0, s27, 10240
    s_add_u32 s8, s26, 14464
    buffer_load_dwordx4 v11, s[44:47], s8 offen lds
    s_add_u32 m0, s27, 11264
    s_add_u32 s8, s26, 21632
    buffer_load_dwordx4 v12, s[44:47], s8 offen lds
rd1_59:
    s_add_u32 m0, s39, 57344
    s_add_u32 s8, s38, 0
    buffer_load_dwordx4 v13, s[48:51], s8 offen lds
    s_add_u32 m0, s39, 58368
    s_add_u32 s8, s38, 7168
    buffer_load_dwordx4 v13, s[48:51], s8 offen lds
    s_add_u32 m0, s39, 59392
    s_add_u32 s8, s38, 14336
    buffer_load_dwordx4 v13, s[48:51], s8 offen lds
    s_add_u32 m0, s39, 60416
    s_add_u32 s8, s38, 21504
    buffer_load_dwordx4 v13, s[48:51], s8 offen lds
    s_add_u32 m0, s39, 61440
    s_add_u32 s8, s38, 28672
    buffer_load_dwordx4 v13, s[48:51], s8 offen lds
    s_add_u32 m0, s39, 62464
    s_add_u32 s8, s38, 35840
    buffer_load_dwordx4 v13, s[48:51], s8 offen lds
    s_add_u32 m0, s39, 63488
    s_add_u32 s8, s38, 43008
    buffer_load_dwordx4 v13, s[48:51], s8 offen lds
    s_add_u32 m0, s39, 64512
    s_add_u32 s8, s38, 50176
    buffer_load_dwordx4 v13, s[48:51], s8 offen lds
    s_waitcnt vmcnt(8)
    s_mov_b64 exec, 1
    ds_add_u32 v0, v29 offset:44
    s_mov_b64 exec, -1
    s_cmp_eq_u32 s76, 1
    s_cbranch_scc1 rd2_60
    s_add_u32 m0, s39, 65536
    s_add_u32 s8, s38, 57344
    buffer_load_dwordx4 v13, s[48:51], s8 offen lds
    s_add_u32 m0, s39, 66560
    s_add_u32 s8, s38, 64512
    buffer_load_dwordx4 v13, s[48:51], s8 offen lds
    s_add_u32 m0, s39, 67584
    s_add_u32 s8, s38, 71680
    buffer_load_dwordx4 v13, s[48:51], s8 offen lds
    s_add_u32 m0, s39, 68608
    s_add_u32 s8, s38, 78848
    buffer_load_dwordx4 v13, s[48:51], s8 offen lds
    s_add_u32 m0, s39, 69632
    s_add_u32 s8, s38, 86016
    buffer_load_dwordx4 v13, s[48:51], s8 offen lds
    s_add_u32 m0, s39, 70656
    s_add_u32 s8, s38, 93184
    buffer_load_dwordx4 v13, s[48:51], s8 offen lds
    s_add_u32 m0, s39, 71680
    s_add_u32 s8, s38, 100352
    buffer_load_dwordx4 v13, s[48:51], s8 offen lds
    s_add_u32 m0, s39, 72704
    s_add_u32 s8, s38, 107520
    buffer_load_dwordx4 v13, s[48:51], s8 offen lds
rd2_60:
    s_waitcnt lgkmcnt(0)
    s_mul_i32 s42, s42, 0x9e3779b5
    s_mul_i32 s43, s43, 0x85ebca6d
    s_add_u32 s42, s42, 0x7f4a7c15
    s_add_u32 s43, s43, 0x165667b1
    s_mov_b32 s52, s30
    s_mov_b32 s53, s31
    s_mov_b32 s54, 3584
    s_mov_b32 s55, 0x20000
    s_lshr_b32 s85, s84, 1
    s_and_b32 s86, s84, 1
    s_lshl_b32 s87, s84, 11
    s_add_u32 s87, s87, 49152
    v_lshlrev_b32 v50, 2, v10
    v_xor_b32 v50, v50, v6
    v_lshlrev_b32 v50, 4, v50
    v_lshl_add_u32 v56, v8, 7, v9
    v_lshlrev_b32 v24, 5, v8
    v_and_b32 v24, 64, v24
    v_add_u32 v56, v56, v24
    v_add_u32 v56, s87, v56
    s_lshr_b32 s8, s4, 3
    s_mul_i32 s8, s8, 6
    s_add_u32 s8, s8, s6
    s_cmp_lt_u32 s6, 6
    s_cselect_b32 s98, 1, 0
    s_and_b32 s9, s2, 0xf9
    s_cmp_eq_u32 s9, 48
    s_cselect_b32 s8, 24, s8
    s_cselect_b32 s98, 1, s98
    s_and_b32 s9, s3, 1
    s_mul_i32 s9, s9, 25
    s_add_u32 s8, s8, s9
    s_mul_i32 s88, s8, 37
    s_lshr_b32 s88, s88, 8
    s_mul_i32 s9, s88, 7
    s_sub_u32 s17, s8, s9
    s_lshr_b32 s91, s3, 1
    s_mul_i32 s91, s91, 7
    s_add_u32 s91, s91, s17
    s_waitcnt vmcnt(0)
    s_mov_b64 exec, 1
    ds_add_u32 v0, v29 offset:0
    s_mov_b64 exec, -1
    v_mul_u32_u24 v48, 3584, v5
    v_add_u32 v48, v48, v50
    v_lshl_add_u32 v49, v5, 12, v50
    v_mul_u32_u24 v24, 896, v5
    v_add_u32 v50, v24, v50
    s_mul_i32 s89, s84, 1835008
    s_lshl_b32 s8, s91, 7
    s_add_u32 s89, s89, s8
    s_lshl_b32 s9, s85, 6
    s_add_u32 s28, s8, s9
    v_lshl_add_u32 v24, v3, 10, v56
    v_xor_b32 v52, s9, v24
    v_xor_b32 v53, 64, v52
    v_add_u32 v240, 0x10000, v52
    v_add_u32 v241, 0x10000, v53
    s_lshl_b32 s8, s86, 10
    v_add_u32 v58, s8, v4
    v_xor_b32 v59, 0x400, v58
    s_lshl_b32 s90, s88, 18
    s_lshl_b32 s8, s84, 16
    s_add_u32 s90, s90, s8
    s_add_u32 s81, s17, 1
    s_lshl_b32 s17, s81, 13
    s_add_u32 s17, s17, s90
    v_lshlrev_b32 v62, 7, v1
    v_add_u32 v247, s87, v4
    v_add_u32 v248, 0x10000, v247
    s_lshr_b32 s16, s88, 1
    s_lshl_b32 s16, s16, 10
    s_lshl_b32 s8, s84, 8
    s_add_u32 s16, s16, s8
    s_lshl_b32 s16, s16, 3
    s_add_u32 s16, s16, 10485760
    v_bfe_u32 v32, v2, 1, 3
    v_lshlrev_b32 v32, 4, v32
    v_xor_b32 v32, s9, v32
    v_lshl_add_u32 v32, v2, 7, v32
    v_lshl_add_u32 v32, v3, 3, v32
    s_lshl_b32 s8, s6, 13
    s_lshl_b32 s9, s86, 12
    s_add_u32 s8, s8, s9
    v_add_u32 v32, s8, v32
    v_xor_b32 v33, 16, v32
    v_xor_b32 v34, 32, v32
    v_xor_b32 v35, 48, v32
    s_branch spe_62
spin_61:
    s_sleep 1
spe_62:
    ds_read_b32 v28, v0 offset:48
    s_waitcnt lgkmcnt(0)
    v_readfirstlane_b32 s13, v28
    s_cmp_lt_u32 s13, 1
    s_cbranch_scc1 spin_61
    s_branch gpfw_58
gh_57:
    s_sub_u32 s9, s6, 4
    s_lshl_b32 s8, s5, 2
    s_add_u32 s8, s8, s9
    s_lshl_b32 s9, s9, 4
    s_lshl_b32 s10, s84, 2
    s_add_u32 s9, s9, s10
    v_add_u32 v11, s9, v7
    v_and_b32 v13, 1, v5
    v_lshlrev_b32 v12, 13, v13
    v_lshl_add_u32 v12, v11, 7, v12
    v_lshl_add_u32 v12, v6, 4, v12
    v_bfe_u32 v11, v11, 1, 3
    v_xor_b32 v11, v11, v6
    v_mul_u32_u24 v14, 912, v7
    v_lshl_add_u32 v14, v11, 4, v14
    v_lshl_add_u32 v14, v13, 7, v14
    s_mul_i32 s10, s84, 3648
    s_add_u32 s10, s10, 114688
    v_add_u32 v14, s10, v14
    v_lshl_add_u32 v15, v3, 3, v8
    v_mul_u32_u24 v15, 912, v15
    v_add_u32 v15, v15, v9
    s_lshl_b32 s10, s84, 8
    s_add_u32 s10, s10, 114688
    v_add_u32 v15, s10, v15
    s_lshl_b32 s10, s84, 19
    s_lshl_b32 s11, s8, 11
    s_add_u32 s10, s10, s11
    s_add_u32 s11, s10, 262144
    s_lshl_b32 s12, s84, 7
    s_add_u32 s12, s12, s8
    s_lshl_b32 s12, s12, 6
    s_add_u32 s12, s12, 10485760
    v_mov_b32 v17, 0xffff0000
    s_mov_b32 vcc_lo, 0x00ff00ff
    s_mov_b32 vcc_hi, 0x00ff00ff
    v_mov_b32 v140, 0
    v_mov_b32 v141, 0
    v_mov_b32 v142, 0
    v_mov_b32 v143, 0
    v_mov_b32 v32, 0
    v_mov_b32 v33, 0
    s_barrier
    s_setprio 3
    s_branch spe_64
spin_63:
    s_sleep 1
spe_64:
    ds_read_b32 v28, v0 offset:40
    s_waitcnt lgkmcnt(0)
    v_readfirstlane_b32 s13, v28
    s_cmp_lt_u32 s13, 4
    s_cbranch_scc1 spin_63
    ds_read_b128 v[128:131], v12 offset:0
    ds_read_b128 v[132:135], v12 offset:16384
    ds_read_b128 v[136:139], v12 offset:32768
    s_mov_b64 exec, vcc
    ds_read_b128 v[140:143], v12 offset:49152
    s_mov_b64 exec, -1
    s_waitcnt lgkmcnt(3)
    v_dot2c_f32_bf16 v32, s82, v128
    v_dot2c_f32_bf16 v33, v128, v128
    v_dot2c_f32_bf16 v32, s82, v129
    v_dot2c_f32_bf16 v33, v129, v129
    v_dot2c_f32_bf16 v32, s82, v130
    v_dot2c_f32_bf16 v33, v130, v130
    v_dot2c_f32_bf16 v32, s82, v131
    v_dot2c_f32_bf16 v33, v131, v131
    s_waitcnt lgkmcnt(2)
    v_dot2c_f32_bf16 v32, s82, v132
    v_dot2c_f32_bf16 v33, v132, v132
    v_dot2c_f32_bf16 v32, s82, v133
    v_dot2c_f32_bf16 v33, v133, v133
    v_dot2c_f32_bf16 v32, s82, v134
    v_dot2c_f32_bf16 v33, v134, v134
    v_dot2c_f32_bf16 v32, s82, v135
    v_dot2c_f32_bf16 v33, v135, v135
    s_waitcnt lgkmcnt(1)
    v_dot2c_f32_bf16 v32, s82, v136
    v_dot2c_f32_bf16 v33, v136, v136
    v_dot2c_f32_bf16 v32, s82, v137
    v_dot2c_f32_bf16 v33, v137, v137
    v_dot2c_f32_bf16 v32, s82, v138
    v_dot2c_f32_bf16 v33, v138, v138
    v_dot2c_f32_bf16 v32, s82, v139
    v_dot2c_f32_bf16 v33, v139, v139
    s_waitcnt lgkmcnt(0)
    v_dot2c_f32_bf16 v32, s82, v140
    v_dot2c_f32_bf16 v33, v140, v140
    v_dot2c_f32_bf16 v32, s82, v141
    v_dot2c_f32_bf16 v33, v141, v141
    v_dot2c_f32_bf16 v32, s82, v142
    v_dot2c_f32_bf16 v33, v142, v142
    v_dot2c_f32_bf16 v32, s82, v143
    v_dot2c_f32_bf16 v33, v143, v143
    v_lshlrev_b32 v160, 16, v128
    v_and_b32 v161, v17, v128
    v_lshlrev_b32 v162, 16, v129
    v_add_f32_dpp v32, v32, v32 quad_perm:[1,0,3,2] row_mask:0xf bank_mask:0xf
    v_add_f32_dpp v33, v33, v33 quad_perm:[1,0,3,2] row_mask:0xf bank_mask:0xf
    v_and_b32 v163, v17, v129
    v_add_f32_dpp v32, v32, v32 quad_perm:[2,3,0,1] row_mask:0xf bank_mask:0xf
    v_add_f32_dpp v33, v33, v33 quad_perm:[2,3,0,1] row_mask:0xf bank_mask:0xf
    v_lshlrev_b32 v164, 16, v130
    v_add_f32_dpp v32, v32, v32 row_half_mirror row_mask:0xf bank_mask:0xf
    v_add_f32_dpp v33, v33, v33 row_half_mirror row_mask:0xf bank_mask:0xf
    v_and_b32 v165, v17, v130
    v_add_f32_dpp v32, v32, v32 row_mirror row_mask:0xf bank_mask:0xf
    v_add_f32_dpp v33, v33, v33 row_mirror row_mask:0xf bank_mask:0xf
    v_lshlrev_b32 v166, 16, v131
    v_mul_f32 v32, 0x3b124925, v32
    v_mul_f32 v33, 0x3b124925, v33
    v_fma_f32 v33, -v32, v32, v33
    v_max_f32 v33, 0, v33
    v_cvt_pk_bf16_f32 v34, v32, v33
    v_lshlrev_b32 v38, 16, v34
    v_and_b32 v34, v17, v34
    v_add_f32 v34, 0x3727c5ac, v34
    v_cvt_pk_bf16_f32 v34, v34, v34
    v_and_b32 v34, v17, v34
    v_sqrt_f32 v34, v34
    v_and_b32 v167, v17, v131
    v_cvt_pk_bf16_f32 v34, v34, v34
    v_and_b32 v34, v17, v34
    v_rcp_f32 v36, v34
    v_lshlrev_b32 v168, 16, v132
    v_sub_f32 v32, v32, v38
    v_mul_f32 v32, v32, v36
    v_mul_f32 v33, v33, v36
    v_mul_f32 v33, v33, v36
    v_cvt_pk_bf16_f32 v34, v32, v33
    v_lshlrev_b32 v32, 16, v34
    v_fma_f32 v38, v38, v36, v32
    v_and_b32 v34, v17, v34
    v_add_f32 v34, 0x3727c5ac, v34
    v_cvt_pk_bf16_f32 v34, v34, v34
    v_and_b32 v34, v17, v34
    v_sqrt_f32 v34, v34
    v_and_b32 v169, v17, v132
    v_cvt_pk_bf16_f32 v34, v34, v34
    v_and_b32 v34, v17, v34
    v_rcp_f32 v37, v34
    v_lshlrev_b32 v170, 16, v133
    v_and_b32 v171, v17, v133
    v_lshlrev_b32 v172, 16, v134
    v_and_b32 v173, v17, v134
    v_lshlrev_b32 v174, 16, v135
    v_and_b32 v175, v17, v135
    v_lshlrev_b32 v176, 16, v136
    v_and_b32 v177, v17, v136
    v_lshlrev_b32 v178, 16, v137
    v_and_b32 v179, v17, v137
    v_lshlrev_b32 v180, 16, v138
    v_and_b32 v181, v17, v138
    v_lshlrev_b32 v182, 16, v139
    v_and_b32 v183, v17, v139
    v_lshlrev_b32 v184, 16, v140
    v_and_b32 v185, v17, v140
    v_lshlrev_b32 v186, 16, v141
    v_and_b32 v187, v17, v141
    v_lshlrev_b32 v188, 16, v142
    v_and_b32 v189, v17, v142
    v_lshlrev_b32 v190, 16, v143
    v_and_b32 v191, v17, v143
    v_mul_f32 v38, v38, v37
    v_mul_f32 v36, v36, v37
    v_pk_fma_f32 v[160:161], v[160:161], v[36:37], v[38:39] op_sel_hi:[1,0,0] neg_lo:[0,0,1] neg_hi:[0,0,1]
    v_cvt_pk_bf16_f32 v128, v160, v161
    v_pk_fma_f32 v[162:163], v[162:163], v[36:37], v[38:39] op_sel_hi:[1,0,0] neg_lo:[0,0,1] neg_hi:[0,0,1]
    v_cvt_pk_bf16_f32 v129, v162, v163
    v_pk_fma_f32 v[164:165], v[164:165], v[36:37], v[38:39] op_sel_hi:[1,0,0] neg_lo:[0,0,1] neg_hi:[0,0,1]
    v_cvt_pk_bf16_f32 v130, v164, v165
    v_pk_fma_f32 v[166:167], v[166:167], v[36:37], v[38:39] op_sel_hi:[1,0,0] neg_lo:[0,0,1] neg_hi:[0,0,1]
    v_cvt_pk_bf16_f32 v131, v166, v167
    ds_write_b128 v14, v[128:131] offset:0
    v_pk_fma_f32 v[168:169], v[168:169], v[36:37], v[38:39] op_sel_hi:[1,0,0] neg_lo:[0,0,1] neg_hi:[0,0,1]
    v_cvt_pk_bf16_f32 v132, v168, v169
    v_pk_fma_f32 v[170:171], v[170:171], v[36:37], v[38:39] op_sel_hi:[1,0,0] neg_lo:[0,0,1] neg_hi:[0,0,1]
    v_cvt_pk_bf16_f32 v133, v170, v171
    v_pk_fma_f32 v[172:173], v[172:173], v[36:37], v[38:39] op_sel_hi:[1,0,0] neg_lo:[0,0,1] neg_hi:[0,0,1]
    v_cvt_pk_bf16_f32 v134, v172, v173
    v_pk_fma_f32 v[174:175], v[174:175], v[36:37], v[38:39] op_sel_hi:[1,0,0] neg_lo:[0,0,1] neg_hi:[0,0,1]
    v_cvt_pk_bf16_f32 v135, v174, v175
    ds_write_b128 v14, v[132:135] offset:256
    v_pk_fma_f32 v[176:177], v[176:177], v[36:37], v[38:39] op_sel_hi:[1,0,0] neg_lo:[0,0,1] neg_hi:[0,0,1]
    v_cvt_pk_bf16_f32 v136, v176, v177
    v_pk_fma_f32 v[178:179], v[178:179], v[36:37], v[38:39] op_sel_hi:[1,0,0] neg_lo:[0,0,1] neg_hi:[0,0,1]
    v_cvt_pk_bf16_f32 v137, v178, v179
    v_pk_fma_f32 v[180:181], v[180:181], v[36:37], v[38:39] op_sel_hi:[1,0,0] neg_lo:[0,0,1] neg_hi:[0,0,1]
    v_cvt_pk_bf16_f32 v138, v180, v181
    v_pk_fma_f32 v[182:183], v[182:183], v[36:37], v[38:39] op_sel_hi:[1,0,0] neg_lo:[0,0,1] neg_hi:[0,0,1]
    v_cvt_pk_bf16_f32 v139, v182, v183
    ds_write_b128 v14, v[136:139] offset:512
    s_mov_b64 exec, vcc
    v_pk_fma_f32 v[184:185], v[184:185], v[36:37], v[38:39] op_sel_hi:[1,0,0] neg_lo:[0,0,1] neg_hi:[0,0,1]
    v_cvt_pk_bf16_f32 v140, v184, v185
    v_pk_fma_f32 v[186:187], v[186:187], v[36:37], v[38:39] op_sel_hi:[1,0,0] neg_lo:[0,0,1] neg_hi:[0,0,1]
    v_cvt_pk_bf16_f32 v141, v186, v187
    v_pk_fma_f32 v[188:189], v[188:189], v[36:37], v[38:39] op_sel_hi:[1,0,0] neg_lo:[0,0,1] neg_hi:[0,0,1]
    v_cvt_pk_bf16_f32 v142, v188, v189
    v_pk_fma_f32 v[190:191], v[190:191], v[36:37], v[38:39] op_sel_hi:[1,0,0] neg_lo:[0,0,1] neg_hi:[0,0,1]
    v_cvt_pk_bf16_f32 v143, v190, v191
    ds_write_b128 v14, v[140:143] offset:768
    s_mov_b64 exec, -1
    s_mov_b64 exec, 1
    ds_add_u32 v0, v29 offset:8
    s_mov_b64 exec, -1
    s_branch spe_66
spin_65:
    s_sleep 1
spe_66:
    ds_read_b32 v28, v0 offset:8
    s_waitcnt lgkmcnt(0)
    v_readfirstlane_b32 s13, v28
    s_cmp_lt_u32 s13, 4
    s_cbranch_scc1 spin_65
    ds_read_b64_tr_b16 v[160:161], v15 offset:0
    ds_read_b64_tr_b16 v[162:163], v15 offset:3648
    ds_read_b64_tr_b16 v[164:165], v15 offset:64
    ds_read_b64_tr_b16 v[166:167], v15 offset:3712
    ds_read_b64_tr_b16 v[168:169], v15 offset:128
    ds_read_b64_tr_b16 v[170:171], v15 offset:3776
    ds_read_b64_tr_b16 v[172:173], v15 offset:192
    ds_read_b64_tr_b16 v[174:175], v15 offset:3840
    s_waitcnt lgkmcnt(6)
    buffer_store_dwordx4 v[160:163], v4, s[56:59], s10 offen offset:0 sc1
    s_waitcnt lgkmcnt(4)
    buffer_store_dwordx4 v[164:167], v4, s[56:59], s10 offen offset:1024 sc1
    s_waitcnt lgkmcnt(2)
    buffer_store_dwordx4 v[168:171], v4, s[56:59], s11 offen offset:0 sc1
    s_waitcnt lgkmcnt(0)
    buffer_store_dwordx4 v[172:175], v4, s[56:59], s11 offen offset:1024 sc1
    s_mov_b64 exec, 1
    ds_add_u32 v0, v29 offset:48
    s_mov_b64 exec, -1
    s_mov_b32 s52, s30
    s_mov_b32 s53, s31
    s_mov_b32 s54, 3584
    s_mov_b32 s55, 0x20000
    s_lshr_b32 s85, s84, 1
    s_and_b32 s86, s84, 1
    s_lshl_b32 s87, s84, 11
    s_add_u32 s87, s87, 49152
    v_lshlrev_b32 v50, 2, v10
    v_xor_b32 v50, v50, v6
    v_lshlrev_b32 v50, 4, v50
    v_lshl_add_u32 v56, v8, 7, v9
    v_lshlrev_b32 v24, 5, v8
    v_and_b32 v24, 64, v24
    v_add_u32 v56, v56, v24
    v_add_u32 v56, s87, v56
    s_lshr_b32 s8, s4, 3
    s_mul_i32 s8, s8, 6
    s_add_u32 s8, s8, s6
    s_cmp_lt_u32 s6, 6
    s_cselect_b32 s98, 1, 0
    s_and_b32 s9, s2, 0xf9
    s_cmp_eq_u32 s9, 48
    s_cselect_b32 s8, 24, s8
    s_cselect_b32 s98, 1, s98
    s_and_b32 s9, s3, 1
    s_mul_i32 s9, s9, 25
    s_add_u32 s8, s8, s9
    s_mul_i32 s88, s8, 37
    s_lshr_b32 s88, s88, 8
    s_mul_i32 s9, s88, 7
    s_sub_u32 s17, s8, s9
    s_lshr_b32 s91, s3, 1
    s_mul_i32 s91, s91, 7
    s_add_u32 s91, s91, s17
    v_mul_u32_u24 v48, 3584, v5
    v_add_u32 v48, v48, v50
    v_lshl_add_u32 v49, v5, 12, v50
    v_mul_u32_u24 v24, 896, v5
    v_add_u32 v50, v24, v50
    s_mul_i32 s89, s84, 1835008
    s_lshl_b32 s8, s91, 7
    s_add_u32 s89, s89, s8
    s_lshl_b32 s9, s85, 6
    s_add_u32 s28, s8, s9
    v_lshl_add_u32 v24, v3, 10, v56
    v_xor_b32 v52, s9, v24
    v_xor_b32 v53, 64, v52
    v_add_u32 v240, 0x10000, v52
    v_add_u32 v241, 0x10000, v53
    s_lshl_b32 s8, s86, 10
    v_add_u32 v58, s8, v4
    v_xor_b32 v59, 0x400, v58
    s_lshl_b32 s90, s88, 18
    s_lshl_b32 s8, s84, 16
    s_add_u32 s90, s90, s8
    s_add_u32 s81, s17, 1
    s_lshl_b32 s17, s81, 13
    s_add_u32 s17, s17, s90
    v_lshlrev_b32 v62, 7, v1
    v_add_u32 v247, s87, v4
    v_add_u32 v248, 0x10000, v247
    s_lshr_b32 s16, s88, 1
    s_lshl_b32 s16, s16, 10
    s_lshl_b32 s8, s84, 8
    s_add_u32 s16, s16, s8
    s_lshl_b32 s16, s16, 3
    s_add_u32 s16, s16, 10485760
    v_bfe_u32 v32, v2, 1, 3
    v_lshlrev_b32 v32, 4, v32
    v_xor_b32 v32, s9, v32
    v_lshl_add_u32 v32, v2, 7, v32
    v_lshl_add_u32 v32, v3, 3, v32
    s_lshl_b32 s8, s6, 13
    s_lshl_b32 s9, s86, 12
    s_add_u32 s8, s8, s9
    v_add_u32 v32, s8, v32
    v_xor_b32 v33, 16, v32
    v_xor_b32 v34, 32, v32
    v_xor_b32 v35, 48, v32
    s_waitcnt lgkmcnt(0)
    s_mul_i32 s42, s42, 0x9e3779b5
    s_mul_i32 s43, s43, 0x85ebca6d
    s_add_u32 s42, s42, 0x7f4a7c15
    s_add_u32 s43, s43, 0x165667b1
    v_mov_b32 v30, s42
    v_mov_b32 v31, s43
    s_waitcnt vmcnt(0)
    s_mov_b64 exec, 1
    buffer_store_dwordx2 v[30:31], off, s[56:59], s12 sc1
    s_mov_b64 exec, -1
    s_setprio 0
    s_branch spe_68
spin_67:
    s_sleep 1
spe_68:
    ds_read_b32 v28, v0 offset:48
    s_waitcnt lgkmcnt(0)
    v_readfirstlane_b32 s13, v28
    s_cmp_lt_u32 s13, 4
    s_cbranch_scc1 spin_67
    s_branch spe_70
spin_69:
    s_sleep 1
spe_70:
    ds_read_b32 v28, v0 offset:20
    s_waitcnt lgkmcnt(0)
    v_readfirstlane_b32 s13, v28
    s_cmp_lt_u32 s13, 4
    s_cbranch_scc1 spin_69
gpfw_58:
    s_branch spe_74
spin_73:
    s_sleep 1
spe_74:
    ds_read_b32 v28, v0 offset:40
    s_waitcnt lgkmcnt(0)
    v_readfirstlane_b32 s13, v28
    s_cmp_lt_u32 s13, 4
    s_cbranch_scc1 spin_73
    s_branch spe_76
spin_75:
    s_sleep 1
spe_76:
    ds_read_b32 v28, v0 offset:44
    s_waitcnt lgkmcnt(0)
    v_readfirstlane_b32 s13, v28
    s_cmp_lt_u32 s13, 4
    s_cbranch_scc1 spin_75
    ds_read_b64 v[80:81], v32 offset:0
    ds_read_b64 v[82:83], v33 offset:0
    ds_read_b64 v[84:85], v34 offset:0
    ds_read_b64 v[86:87], v35 offset:0
    s_mov_b64 exec, 1
    ds_add_u32 v0, v29 offset:12
    s_mov_b64 exec, -1
    s_cmp_eq_u32 s98, 0
    s_cbranch_scc1 nog1_71
    s_setprio 0
    v_add_u32 v249, 27648, v48
    v_add_u32 v250, 31744, v49
    v_lshlrev_b32 v7, 3, v3
    buffer_load_dwordx2 v[88:89], v7, s[52:55], s28 offen offset:0
    buffer_load_dwordx2 v[90:91], v7, s[52:55], s28 offen offset:16
    buffer_load_dwordx2 v[92:93], v7, s[52:55], s28 offen offset:32
    buffer_load_dwordx2 v[94:95], v7, s[52:55], s28 offen offset:48
    s_add_u32 m0, s87, 65536
    s_nop 0
    buffer_load_dwordx4 v48, s[60:63], s89 offen lds
    buffer_load_dwordx4 v249, s[60:63], s89 offen offset:1024 lds
    s_add_u32 s89, s89, 57344
    s_add_u32 m0, s87, 73728
    s_nop 0
    buffer_load_dwordx4 v48, s[60:63], s89 offen lds
    buffer_load_dwordx4 v249, s[60:63], s89 offen offset:1024 lds
    s_add_u32 s89, s89, 57344
    s_add_u32 m0, s87, 81920
    s_nop 0
    buffer_load_dwordx4 v48, s[60:63], s89 offen lds
    buffer_load_dwordx4 v249, s[60:63], s89 offen offset:1024 lds
    s_add_u32 s89, s89, 57344
    s_add_u32 m0, s87, 90112
    s_nop 0
    buffer_load_dwordx4 v48, s[60:63], s89 offen lds
    buffer_load_dwordx4 v249, s[60:63], s89 offen offset:1024 lds
    s_add_u32 s89, s89, 57344
    buffer_load_dwordx4 v[168:171], v48, s[60:63], s89 offen
    s_add_u32 s89, s89, 28672
    buffer_load_dwordx4 v[172:175], v48, s[60:63], s89 offen
    s_add_u32 s89, s89, 28672
    buffer_load_dwordx4 v[176:179], v48, s[60:63], s89 offen
    s_add_u32 s89, s89, 28672
    buffer_load_dwordx4 v[180:183], v48, s[60:63], s89 offen
    s_add_u32 s89, s89, 28672
    buffer_load_dwordx4 v[184:187], v48, s[60:63], s89 offen
    s_add_u32 s89, s89, 28672
    buffer_load_dwordx4 v[188:191], v48, s[60:63], s89 offen
    s_add_u32 s89, s89, 28672
    buffer_load_dwordx4 v[192:195], v48, s[60:63], s89 offen
    s_add_u32 s89, s89, 28672
    buffer_load_dwordx4 v[196:199], v48, s[60:63], s89 offen
    s_add_u32 s89, s89, 28672
    buffer_load_dwordx4 v[200:203], v48, s[60:63], s89 offen
    s_add_u32 s89, s89, 28672
    buffer_load_dwordx4 v[204:207], v48, s[60:63], s89 offen
    s_add_u32 s89, s89, 28672
    buffer_load_dwordx4 v[208:211], v48, s[60:63], s89 offen
    s_add_u32 s89, s89, 28672
    buffer_load_dwordx4 v[212:215], v48, s[60:63], s89 offen
    s_add_u32 s89, s89, 28672
    s_mov_b64 exec, 1
    ds_add_u32 v0, v29 offset:52
    s_mov_b64 exec, -1
    v_min_u32 v28, 31, v1
    v_lshlrev_b32 v28, 6, v28
    buffer_load_dwordx2 v[30:31], v28, s[56:59], s16 offen sc1
    s_mov_b32 s64, s32
    s_mov_b32 s65, s33
    s_mov_b32 s66, 7340032
    s_mov_b32 s67, 0x20000
    s_mov_b32 s68, s24
    s_mov_b32 s69, s25
    s_mov_b32 s70, 401408
    s_mov_b32 s71, 0x20000
    s_mov_b32 s72, s36
    s_mov_b32 s73, s37
    s_mov_b32 s74, 1835008
    s_mov_b32 s75, 0x20000
    s_mov_b32 s20, s34
    s_mov_b32 s21, s35
    s_mov_b32 s22, 4096
    s_mov_b32 s23, 0x20000
    s_mul_i32 s92, s84, 1835008
    s_lshl_b32 s8, s5, 7
    s_add_u32 s92, s92, s8
    s_mul_i32 s93, s84, 100352
    s_lshl_b32 s8, s6, 7
    s_add_u32 s93, s93, s8
    s_lshl_b32 s8, s85, 6
    s_lshl_b32 s9, s86, 6
    v_lshl_add_u32 v24, v3, 9, v56
    v_xor_b32 v54, s9, v24
    v_xor_b32 v55, 64, v54
    v_xor_b32 v56, s8, v24
    v_xor_b32 v57, 64, v56
    s_lshl_b32 s8, s85, 10
    v_add_u32 v60, s8, v4
    v_xor_b32 v61, 0x400, v60
    s_mul_i32 s94, s6, 112
    s_mul_i32 s8, s84, 28
    s_add_u32 s94, s94, s8
    s_lshl_b32 s94, s94, 11
    s_add_u32 s94, s94, 5242880
    s_lshr_b32 s8, s4, 3
    s_add_u32 s8, s8, 3
    s_lshl_b32 s8, s8, 13
    s_add_u32 s32, s8, s94
    s_lshl_b32 s95, s5, 16
    s_lshl_b32 s8, s84, 14
    s_add_u32 s95, s95, s8
    s_add_u32 s95, s95, 7340032
    v_mul_u32_u24 v51, 896, v2
    v_lshl_add_u32 v51, v3, 4, v51
    s_lshl_b32 s8, s5, 1
    s_add_u32 s8, s8, s86
    s_lshl_b32 s97, s8, 6
    s_mul_i32 s8, s8, 28672
    s_lshl_b32 s9, s6, 7
    s_add_u32 s8, s8, s9
    s_lshl_b32 s9, s85, 6
    s_add_u32 s96, s8, s9
    v_lshrrev_b32 v63, 2, v1
    v_and_b32 v24, 3, v1
    v_lshlrev_b32 v63, 12, v63
    v_lshl_add_u32 v63, v24, 7, v63
    s_mul_i32 s8, s88, 112
    s_lshl_b32 s9, s91, 2
    s_add_u32 s8, s8, s9
    s_lshl_b32 s10, s85, 1
    s_add_u32 s8, s8, s10
    s_lshl_b32 s8, s8, 11
    s_add_u32 s30, s8, 5242880
    s_lshl_b32 s8, s88, 7
    s_add_u32 s8, s8, s9
    s_add_u32 s8, s8, s84
    s_lshl_b32 s8, s8, 3
    s_lshl_b32 s8, s8, 3
    s_add_u32 s29, s8, 10682368
    s_lshl_b32 s8, s6, 10
    s_mul_i32 s9, s84, 224
    s_add_u32 s8, s8, s9
    s_lshl_b32 s8, s8, 3
    s_add_u32 s31, s8, 10682368
    s_lshl_b32 s8, s5, 8
    s_lshl_b32 s9, s84, 6
    s_add_u32 s8, s8, s9
    s_lshl_b32 s8, s8, 3
    s_add_u32 s33, s8, 10813440
    v_add_u32 v242, 0x10000, v54
    v_add_u32 v243, 0x10000, v55
    v_add_u32 v244, 0x10000, v56
    v_add_u32 v245, 0x10000, v57
    s_lshr_b32 s8, s4, 3
    s_mul_i32 s8, s8, 0
    s_mul_i32 s9, s3, 4
    s_add_u32 s8, s8, s9
    s_mul_i32 s9, s8, 2341
    s_lshr_b32 s9, s9, 16
    s_mul_i32 s9, s9, 28
    s_sub_u32 s8, s8, s9
    s_mov_b32 s34, s94
    s_add_u32 s35, s94, 57344
    s_mov_b32 s36, s92
    s_add_u32 s37, s92, 1835008
    s_lshl_b32 s9, s8, 11
    s_add_u32 s94, s94, s9
    s_lshl_b32 s9, s8, 16
    s_add_u32 s92, s92, s9
    v_lshlrev_b32 v6, 1, v2
    buffer_load_ushort v5, v6, s[20:23], s97 offen
    s_waitcnt vmcnt(1)
    s_setprio 3
    v_cmp_ne_u64 vcc, s[42:43], v[30:31]
    s_setprio 0
    s_cbranch_vccz flok_77
    s_setprio 3
    v_min_u32 v28, 31, v1
    v_lshlrev_b32 v28, 6, v28
    s_mov_b32 s83, 20000
poll_78:
    buffer_load_dwordx2 v[30:31], v28, s[56:59], s16 offen sc1
    s_waitcnt vmcnt(0)
    v_cmp_ne_u64 vcc, s[42:43], v[30:31]
    s_cbranch_vccz polld_79
    s_sub_u32 s83, s83, 1
    s_cmp_lg_u32 s83, 0
    s_cbranch_scc1 poll_78
polld_79:
    s_setprio 0
flok_77:
    s_setprio 3
    buffer_load_dwordx4 v[128:131], v58, s[56:59], s90 offen offset:0 sc1
    buffer_load_dwordx4 v[132:135], v59, s[56:59], s90 offen offset:0 sc1
    buffer_load_dwordx4 v[136:139], v58, s[56:59], s90 offen offset:2048 sc1
    buffer_load_dwordx4 v[140:143], v59, s[56:59], s90 offen offset:2048 sc1
    s_add_u32 s90, s90, 4096
    buffer_load_dwordx4 v[144:147], v58, s[56:59], s90 offen offset:0 sc1
    buffer_load_dwordx4 v[148:151], v59, s[56:59], s90 offen offset:0 sc1
    buffer_load_dwordx4 v[152:155], v58, s[56:59], s90 offen offset:2048 sc1
    buffer_load_dwordx4 v[156:159], v59, s[56:59], s90 offen offset:2048 sc1
    s_add_u32 s90, s90, 4096
    v_lshlrev_b32 v64, 16, v88
    v_and_b32 v65, 0xffff0000, v88
    v_lshlrev_b32 v66, 16, v89
    v_and_b32 v67, 0xffff0000, v89
    v_lshlrev_b32 v68, 16, v90
    v_and_b32 v69, 0xffff0000, v90
    v_lshlrev_b32 v70, 16, v91
    v_and_b32 v71, 0xffff0000, v91
    v_lshlrev_b32 v72, 16, v92
    v_and_b32 v73, 0xffff0000, v92
    v_lshlrev_b32 v74, 16, v93
    v_and_b32 v75, 0xffff0000, v93
    v_lshlrev_b32 v76, 16, v94
    v_and_b32 v77, 0xffff0000, v94
    v_lshlrev_b32 v78, 16, v95
    v_and_b32 v79, 0xffff0000, v95
    s_xor_b32 s8, s84, 0
    s_mul_i32 s9, s8, 12288
    s_add_u32 s9, s9, 0
    v_add_u32 v24, s9, v4
    s_xor_b32 s8, s84, 1
    s_mul_i32 s9, s8, 12288
    s_add_u32 s9, s9, 0
    v_add_u32 v25, s9, v4
    s_xor_b32 s8, s84, 2
    s_mul_i32 s9, s8, 12288
    s_add_u32 s9, s9, 0
    v_add_u32 v26, s9, v4
    s_xor_b32 s8, s84, 3
    s_mul_i32 s9, s8, 12288
    s_add_u32 s9, s9, 0
    v_add_u32 v27, s9, v4
    v_mov_b32 v7, 0xc0135761
    s_waitcnt vmcnt(8) lgkmcnt(0)
    v_lshlrev_b32 v5, 16, v5
    v_lshlrev_b32 v8, 16, v80
    v_and_b32 v9, 0xffff0000, v80
    v_lshlrev_b32 v10, 16, v81
    v_and_b32 v11, 0xffff0000, v81
    v_lshlrev_b32 v12, 16, v82
    v_and_b32 v13, 0xffff0000, v82
    v_lshlrev_b32 v14, 16, v83
    v_and_b32 v15, 0xffff0000, v83
    v_lshlrev_b32 v16, 16, v84
    v_and_b32 v17, 0xffff0000, v84
    v_lshlrev_b32 v18, 16, v85
    v_and_b32 v19, 0xffff0000, v85
    v_lshlrev_b32 v20, 16, v86
    v_and_b32 v21, 0xffff0000, v86
    v_lshlrev_b32 v22, 16, v87
    v_and_b32 v23, 0xffff0000, v87
    v_add_f32 v8, v5, v8
    v_add_f32 v9, v5, v9
    v_add_f32 v10, v5, v10
    v_add_f32 v11, v5, v11
    v_add_f32 v12, v5, v12
    v_add_f32 v13, v5, v13
    v_add_f32 v14, v5, v14
    v_add_f32 v15, v5, v15
    v_add_f32 v16, v5, v16
    v_add_f32 v17, v5, v17
    v_add_f32 v18, v5, v18
    v_add_f32 v19, v5, v19
    v_add_f32 v20, v5, v20
    v_add_f32 v21, v5, v21
    v_add_f32 v22, v5, v22
    v_add_f32 v23, v5, v23
    v_min_u32 v251, 27, v1
    v_lshlrev_b32 v251, 6, v251
    v_min_u32 v252, 7, v1
    v_lshlrev_b32 v252, 6, v252
    ds_read_b64_tr_b16 v[32:33], v240 offset:0
    ds_read_b64_tr_b16 v[34:35], v240 offset:512
    ds_read_b64_tr_b16 v[36:37], v241 offset:0
    ds_read_b64_tr_b16 v[38:39], v241 offset:512
    s_setprio 0
    s_waitcnt vmcnt(6) lgkmcnt(0)
    v_mfma_f32_32x32x16_bf16 v[64:79], v[32:35], v[128:131], v[64:79]
    ds_read_b64_tr_b16 v[40:41], v240 offset:8192
    ds_read_b64_tr_b16 v[42:43], v240 offset:8704
    ds_read_b64_tr_b16 v[44:45], v241 offset:8192
    ds_read_b64_tr_b16 v[46:47], v241 offset:8704
    buffer_load_dwordx4 v[160:163], v58, s[56:59], s90 offen offset:0 sc1
    v_mfma_f32_32x32x16_bf16 v[80:95], v[32:35], v[132:135], 0
    buffer_load_dwordx4 v[164:167], v59, s[56:59], s90 offen offset:0 sc1
    v_mfma_f32_32x32x16_bf16 v[96:111], v[36:39], v[128:131], 0
    v_mfma_f32_32x32x16_bf16 v[112:127], v[36:39], v[132:135], 0
    s_waitcnt vmcnt(6) lgkmcnt(0)
    v_mfma_f32_32x32x16_bf16 v[64:79], v[40:43], v[136:139], v[64:79]
    ds_read_b64_tr_b16 v[32:33], v240 offset:16384
    ds_read_b64_tr_b16 v[34:35], v240 offset:16896
    ds_read_b64_tr_b16 v[36:37], v241 offset:16384
    ds_read_b64_tr_b16 v[38:39], v241 offset:16896
    buffer_load_dwordx4 v[128:131], v58, s[56:59], s90 offen offset:2048 sc1
    v_mfma_f32_32x32x16_bf16 v[80:95], v[40:43], v[140:143], v[80:95]
    buffer_load_dwordx4 v[132:135], v59, s[56:59], s90 offen offset:2048 sc1
    s_add_u32 s90, s90, 4096
    v_mfma_f32_32x32x16_bf16 v[96:111], v[44:47], v[136:139], v[96:111]
    ds_write_b128 v248, v[168:171] offset:0
    ds_write_b128 v248, v[172:175] offset:1024
    v_mfma_f32_32x32x16_bf16 v[112:127], v[44:47], v[140:143], v[112:127]
    s_waitcnt vmcnt(6) lgkmcnt(0)
    v_mfma_f32_32x32x16_bf16 v[64:79], v[32:35], v[144:147], v[64:79]
    ds_read_b64_tr_b16 v[40:41], v240 offset:24576
    ds_read_b64_tr_b16 v[42:43], v240 offset:25088
    ds_read_b64_tr_b16 v[44:45], v241 offset:24576
    ds_read_b64_tr_b16 v[46:47], v241 offset:25088
    buffer_load_dwordx4 v[136:139], v58, s[56:59], s90 offen offset:0 sc1
    v_mfma_f32_32x32x16_bf16 v[80:95], v[32:35], v[148:151], v[80:95]
    buffer_load_dwordx4 v[140:143], v59, s[56:59], s90 offen offset:0 sc1
    v_mfma_f32_32x32x16_bf16 v[96:111], v[36:39], v[144:147], v[96:111]
    ds_write_b128 v248, v[176:179] offset:8192
    ds_write_b128 v248, v[180:183] offset:9216
    v_mfma_f32_32x32x16_bf16 v[112:127], v[36:39], v[148:151], v[112:127]
    s_waitcnt vmcnt(6) lgkmcnt(0)
    v_mfma_f32_32x32x16_bf16 v[64:79], v[40:43], v[152:155], v[64:79]
    ds_read_b64_tr_b16 v[32:33], v240 offset:0
    ds_read_b64_tr_b16 v[34:35], v240 offset:512
    ds_read_b64_tr_b16 v[36:37], v241 offset:0
    ds_read_b64_tr_b16 v[38:39], v241 offset:512
    buffer_load_dwordx4 v[144:147], v58, s[56:59], s90 offen offset:2048 sc1
    v_mfma_f32_32x32x16_bf16 v[80:95], v[40:43], v[156:159], v[80:95]
    buffer_load_dwordx4 v[148:151], v59, s[56:59], s90 offen offset:2048 sc1
    s_add_u32 s90, s90, 4096
    v_mfma_f32_32x32x16_bf16 v[96:111], v[44:47], v[152:155], v[96:111]
    ds_write_b128 v248, v[184:187] offset:16384
    ds_write_b128 v248, v[188:191] offset:17408
    v_mfma_f32_32x32x16_bf16 v[112:127], v[44:47], v[156:159], v[112:127]
    s_waitcnt vmcnt(6) lgkmcnt(0)
    v_mfma_f32_32x32x16_bf16 v[64:79], v[32:35], v[160:163], v[64:79]
    ds_read_b64_tr_b16 v[40:41], v240 offset:8192
    ds_read_b64_tr_b16 v[42:43], v240 offset:8704
    ds_read_b64_tr_b16 v[44:45], v241 offset:8192
    ds_read_b64_tr_b16 v[46:47], v241 offset:8704
    buffer_load_dwordx4 v[152:155], v58, s[56:59], s90 offen offset:0 sc1
    v_mfma_f32_32x32x16_bf16 v[80:95], v[32:35], v[164:167], v[80:95]
    buffer_load_dwordx4 v[156:159], v59, s[56:59], s90 offen offset:0 sc1
    v_mfma_f32_32x32x16_bf16 v[96:111], v[36:39], v[160:163], v[96:111]
    ds_write_b128 v248, v[192:195] offset:24576
    ds_write_b128 v248, v[196:199] offset:25600
    v_mfma_f32_32x32x16_bf16 v[112:127], v[36:39], v[164:167], v[112:127]
    s_waitcnt vmcnt(6) lgkmcnt(0)
    v_mfma_f32_32x32x16_bf16 v[64:79], v[40:43], v[128:131], v[64:79]
    ds_read_b64_tr_b16 v[32:33], v240 offset:16384
    ds_read_b64_tr_b16 v[34:35], v240 offset:16896
    ds_read_b64_tr_b16 v[36:37], v241 offset:16384
    ds_read_b64_tr_b16 v[38:39], v241 offset:16896
    buffer_load_dwordx4 v[160:163], v58, s[56:59], s90 offen offset:2048 sc1
    v_mfma_f32_32x32x16_bf16 v[80:95], v[40:43], v[132:135], v[80:95]
    buffer_load_dwordx4 v[164:167], v59, s[56:59], s90 offen offset:2048 sc1
    s_add_u32 s90, s90, 4096
    v_mfma_f32_32x32x16_bf16 v[96:111], v[44:47], v[128:131], v[96:111]
    ds_write_b128 v248, v[200:203] offset:0
    ds_write_b128 v248, v[204:207] offset:1024
    v_mfma_f32_32x32x16_bf16 v[112:127], v[44:47], v[132:135], v[112:127]
    s_waitcnt vmcnt(6) lgkmcnt(0)
    v_mfma_f32_32x32x16_bf16 v[64:79], v[32:35], v[136:139], v[64:79]
    ds_read_b64_tr_b16 v[40:41], v240 offset:24576
    ds_read_b64_tr_b16 v[42:43], v240 offset:25088
    ds_read_b64_tr_b16 v[44:45], v241 offset:24576
    ds_read_b64_tr_b16 v[46:47], v241 offset:25088
    buffer_load_dwordx4 v[128:131], v58, s[56:59], s90 offen offset:0 sc1
    v_mfma_f32_32x32x16_bf16 v[80:95], v[32:35], v[140:143], v[80:95]
    buffer_load_dwordx4 v[132:135], v59, s[56:59], s90 offen offset:0 sc1
    v_mfma_f32_32x32x16_bf16 v[96:111], v[36:39], v[136:139], v[96:111]
    ds_write_b128 v248, v[208:211] offset:8192
    ds_write_b128 v248, v[212:215] offset:9216
    v_mfma_f32_32x32x16_bf16 v[112:127], v[36:39], v[140:143], v[112:127]
    s_waitcnt vmcnt(6) lgkmcnt(0)
    v_mfma_f32_32x32x16_bf16 v[64:79], v[40:43], v[144:147], v[64:79]
    ds_read_b64_tr_b16 v[32:33], v240 offset:0
    ds_read_b64_tr_b16 v[34:35], v240 offset:512
    ds_read_b64_tr_b16 v[36:37], v241 offset:0
    ds_read_b64_tr_b16 v[38:39], v241 offset:512
    buffer_load_dwordx4 v[136:139], v58, s[56:59], s90 offen offset:2048 sc1
    v_mfma_f32_32x32x16_bf16 v[80:95], v[40:43], v[148:151], v[80:95]
    buffer_load_dwordx4 v[140:143], v59, s[56:59], s90 offen offset:2048 sc1
    s_add_u32 s90, s90, 4096
    s_add_u32 m0, s87, 81920
    v_mfma_f32_32x32x16_bf16 v[96:111], v[44:47], v[144:147], v[96:111]
    buffer_load_dwordx4 v48, s[60:63], s89 offen lds
    v_mfma_f32_32x32x16_bf16 v[112:127], v[44:47], v[148:151], v[112:127]
    buffer_load_dwordx4 v249, s[60:63], s89 offen offset:1024 lds
    s_add_u32 s89, s89, 57344
    s_waitcnt vmcnt(8) lgkmcnt(0)
    s_setprio 3
    s_branch spe_81
spin_80:
    s_sleep 1
spe_81:
    ds_read_b32 v28, v0 offset:16
    s_waitcnt lgkmcnt(0)
    v_readfirstlane_b32 s13, v28
    s_cmp_lt_u32 s13, 4
    s_cbranch_scc1 spin_80
    s_setprio 0
    v_mfma_f32_32x32x16_bf16 v[64:79], v[32:35], v[152:155], v[64:79]
    ds_read_b64_tr_b16 v[40:41], v240 offset:8192
    ds_read_b64_tr_b16 v[42:43], v240 offset:8704
    ds_read_b64_tr_b16 v[44:45], v241 offset:8192
    ds_read_b64_tr_b16 v[46:47], v241 offset:8704
    buffer_load_dwordx4 v[144:147], v58, s[56:59], s90 offen offset:0 sc1
    v_mfma_f32_32x32x16_bf16 v[80:95], v[32:35], v[156:159], v[80:95]
    buffer_load_dwordx4 v[148:151], v59, s[56:59], s90 offen offset:0 sc1
    s_add_u32 m0, s87, 90112
    v_mfma_f32_32x32x16_bf16 v[96:111], v[36:39], v[152:155], v[96:111]
    buffer_load_dwordx4 v48, s[60:63], s89 offen lds
    v_mfma_f32_32x32x16_bf16 v[112:127], v[36:39], v[156:159], v[112:127]
    buffer_load_dwordx4 v249, s[60:63], s89 offen offset:1024 lds
    s_add_u32 s89, s89, 57344
    s_add_u32 m0, s87, 0
    s_nop 0
    buffer_load_dwordx4 v48, s[60:63], s89 offen lds
    buffer_load_dwordx4 v249, s[60:63], s89 offen offset:1024 lds
    s_add_u32 s89, s89, 57344
    s_waitcnt vmcnt(6) lgkmcnt(0)
    v_mfma_f32_32x32x16_bf16 v[64:79], v[40:43], v[160:163], v[64:79]
    ds_read_b64_tr_b16 v[32:33], v240 offset:16384
    ds_read_b64_tr_b16 v[34:35], v240 offset:16896
    ds_read_b64_tr_b16 v[36:37], v241 offset:16384
    ds_read_b64_tr_b16 v[38:39], v241 offset:16896
    buffer_load_dwordx4 v[152:155], v58, s[56:59], s90 offen offset:2048 sc1
    v_mfma_f32_32x32x16_bf16 v[80:95], v[40:43], v[164:167], v[80:95]
    buffer_load_dwordx4 v[156:159], v59, s[56:59], s90 offen offset:2048 sc1
    s_add_u32 s90, s90, 4096
    s_add_u32 m0, s87, 8192
    v_mfma_f32_32x32x16_bf16 v[96:111], v[44:47], v[160:163], v[96:111]
    buffer_load_dwordx4 v48, s[60:63], s89 offen lds
    v_mfma_f32_32x32x16_bf16 v[112:127], v[44:47], v[164:167], v[112:127]
    buffer_load_dwordx4 v249, s[60:63], s89 offen offset:1024 lds
    s_add_u32 s89, s89, 57344
    s_add_u32 m0, s87, 16384
    s_nop 0
    buffer_load_dwordx4 v48, s[60:63], s89 offen lds
    buffer_load_dwordx4 v249, s[60:63], s89 offen offset:1024 lds
    s_add_u32 s89, s89, 57344
    s_waitcnt vmcnt(8) lgkmcnt(0)
    v_mfma_f32_32x32x16_bf16 v[64:79], v[32:35], v[128:131], v[64:79]
    ds_read_b64_tr_b16 v[40:41], v240 offset:24576
    ds_read_b64_tr_b16 v[42:43], v240 offset:25088
    ds_read_b64_tr_b16 v[44:45], v241 offset:24576
    ds_read_b64_tr_b16 v[46:47], v241 offset:25088
    buffer_load_dwordx4 v[160:163], v58, s[56:59], s90 offen offset:0 sc1
    v_mfma_f32_32x32x16_bf16 v[80:95], v[32:35], v[132:135], v[80:95]
    buffer_load_dwordx4 v[164:167], v59, s[56:59], s90 offen offset:0 sc1
    s_add_u32 m0, s87, 24576
    v_mfma_f32_32x32x16_bf16 v[96:111], v[36:39], v[128:131], v[96:111]
    buffer_load_dwordx4 v48, s[60:63], s89 offen lds
    v_mfma_f32_32x32x16_bf16 v[112:127], v[36:39], v[132:135], v[112:127]
    buffer_load_dwordx4 v249, s[60:63], s89 offen offset:1024 lds
    s_add_u32 s89, s89, 57344
    s_add_u32 m0, s87, 32768
    s_nop 0
    buffer_load_dwordx4 v48, s[60:63], s89 offen lds
    buffer_load_dwordx4 v249, s[60:63], s89 offen offset:1024 lds
    s_add_u32 s89, s89, 57344
    s_waitcnt vmcnt(12) lgkmcnt(0)
    v_mfma_f32_32x32x16_bf16 v[64:79], v[40:43], v[136:139], v[64:79]
    ds_read_b64_tr_b16 v[32:33], v52 offset:0
    ds_read_b64_tr_b16 v[34:35], v52 offset:512
    ds_read_b64_tr_b16 v[36:37], v53 offset:0
    ds_read_b64_tr_b16 v[38:39], v53 offset:512
    buffer_load_dwordx4 v[128:131], v58, s[56:59], s90 offen offset:2048 sc1
    v_mfma_f32_32x32x16_bf16 v[80:95], v[40:43], v[140:143], v[80:95]
    buffer_load_dwordx4 v[132:135], v59, s[56:59], s90 offen offset:2048 sc1
    s_add_u32 s90, s90, 4096
    s_add_u32 m0, s87, 40960
    v_mfma_f32_32x32x16_bf16 v[96:111], v[44:47], v[136:139], v[96:111]
    buffer_load_dwordx4 v48, s[60:63], s89 offen lds
    v_mfma_f32_32x32x16_bf16 v[112:127], v[44:47], v[140:143], v[112:127]
    buffer_load_dwordx4 v249, s[60:63], s89 offen offset:1024 lds
    s_add_u32 s89, s89, 57344
    s_waitcnt vmcnt(12) lgkmcnt(0)
    v_mfma_f32_32x32x16_bf16 v[64:79], v[32:35], v[144:147], v[64:79]
    ds_read_b64_tr_b16 v[40:41], v52 offset:8192
    ds_read_b64_tr_b16 v[42:43], v52 offset:8704
    ds_read_b64_tr_b16 v[44:45], v53 offset:8192
    ds_read_b64_tr_b16 v[46:47], v53 offset:8704
    buffer_load_dwordx4 v[136:139], v58, s[56:59], s90 offen offset:0 sc1
    v_mfma_f32_32x32x16_bf16 v[80:95], v[32:35], v[148:151], v[80:95]
    buffer_load_dwordx4 v[140:143], v59, s[56:59], s90 offen offset:0 sc1
    s_add_u32 m0, s87, 49152
    v_mfma_f32_32x32x16_bf16 v[96:111], v[36:39], v[144:147], v[96:111]
    buffer_load_dwordx4 v48, s[60:63], s89 offen lds
    v_mfma_f32_32x32x16_bf16 v[112:127], v[36:39], v[148:151], v[112:127]
    buffer_load_dwordx4 v249, s[60:63], s89 offen offset:1024 lds
    s_add_u32 s89, s89, 57344
    s_waitcnt vmcnt(14) lgkmcnt(0)
    v_mfma_f32_32x32x16_bf16 v[64:79], v[40:43], v[152:155], v[64:79]
    ds_read_b64_tr_b16 v[32:33], v52 offset:16384
    ds_read_b64_tr_b16 v[34:35], v52 offset:16896
    ds_read_b64_tr_b16 v[36:37], v53 offset:16384
    ds_read_b64_tr_b16 v[38:39], v53 offset:16896
    buffer_load_dwordx4 v[144:147], v58, s[56:59], s90 offen offset:2048 sc1
    v_mfma_f32_32x32x16_bf16 v[80:95], v[40:43], v[156:159], v[80:95]
    buffer_load_dwordx4 v[148:151], v59, s[56:59], s90 offen offset:2048 sc1
    s_add_u32 s90, s90, 4096
    s_add_u32 m0, s87, 57344
    v_mfma_f32_32x32x16_bf16 v[96:111], v[44:47], v[152:155], v[96:111]
    buffer_load_dwordx4 v48, s[60:63], s89 offen lds
    v_mfma_f32_32x32x16_bf16 v[112:127], v[44:47], v[156:159], v[112:127]
    buffer_load_dwordx4 v249, s[60:63], s89 offen offset:1024 lds
    s_add_u32 s89, s89, 57344
    s_waitcnt vmcnt(14) lgkmcnt(0)
    v_mfma_f32_32x32x16_bf16 v[64:79], v[32:35], v[160:163], v[64:79]
    ds_read_b64_tr_b16 v[40:41], v52 offset:24576
    ds_read_b64_tr_b16 v[42:43], v52 offset:25088
    ds_read_b64_tr_b16 v[44:45], v53 offset:24576
    ds_read_b64_tr_b16 v[46:47], v53 offset:25088
    buffer_load_dwordx4 v[152:155], v58, s[56:59], s90 offen offset:0 sc1
    v_mfma_f32_32x32x16_bf16 v[80:95], v[32:35], v[164:167], v[80:95]
    buffer_load_dwordx4 v[156:159], v59, s[56:59], s90 offen offset:0 sc1
    s_add_u32 m0, s87, 65536
    v_mfma_f32_32x32x16_bf16 v[96:111], v[36:39], v[160:163], v[96:111]
    buffer_load_dwordx4 v48, s[60:63], s89 offen lds
    v_mfma_f32_32x32x16_bf16 v[112:127], v[36:39], v[164:167], v[112:127]
    buffer_load_dwordx4 v249, s[60:63], s89 offen offset:1024 lds
    s_add_u32 s89, s89, 57344
    s_waitcnt vmcnt(14) lgkmcnt(0)
    v_mfma_f32_32x32x16_bf16 v[64:79], v[40:43], v[128:131], v[64:79]
    ds_read_b64_tr_b16 v[32:33], v52 offset:32768
    ds_read_b64_tr_b16 v[34:35], v52 offset:33280
    ds_read_b64_tr_b16 v[36:37], v53 offset:32768
    ds_read_b64_tr_b16 v[38:39], v53 offset:33280
    buffer_load_dwordx4 v[160:163], v58, s[56:59], s90 offen offset:2048 sc1
    v_mfma_f32_32x32x16_bf16 v[80:95], v[40:43], v[132:135], v[80:95]
    buffer_load_dwordx4 v[164:167], v59, s[56:59], s90 offen offset:2048 sc1
    s_add_u32 s90, s90, 4096
    s_add_u32 m0, s87, 73728
    v_mfma_f32_32x32x16_bf16 v[96:111], v[44:47], v[128:131], v[96:111]
    buffer_load_dwordx4 v48, s[60:63], s89 offen lds
    v_mfma_f32_32x32x16_bf16 v[112:127], v[44:47], v[132:135], v[112:127]
    buffer_load_dwordx4 v249, s[60:63], s89 offen offset:1024 lds
    s_add_u32 s89, s89, 57344
    s_waitcnt vmcnt(14) lgkmcnt(0)
    v_mfma_f32_32x32x16_bf16 v[64:79], v[32:35], v[136:139], v[64:79]
    ds_read_b64_tr_b16 v[40:41], v52 offset:40960
    ds_read_b64_tr_b16 v[42:43], v52 offset:41472
    ds_read_b64_tr_b16 v[44:45], v53 offset:40960
    ds_read_b64_tr_b16 v[46:47], v53 offset:41472
    buffer_load_dwordx4 v[128:131], v58, s[56:59], s90 offen offset:0 sc1
    v_mfma_f32_32x32x16_bf16 v[80:95], v[32:35], v[140:143], v[80:95]
    buffer_load_dwordx4 v[132:135], v59, s[56:59], s90 offen offset:0 sc1
    s_add_u32 m0, s87, 81920
    v_mfma_f32_32x32x16_bf16 v[96:111], v[36:39], v[136:139], v[96:111]
    buffer_load_dwordx4 v48, s[60:63], s89 offen lds
    v_mfma_f32_32x32x16_bf16 v[112:127], v[36:39], v[140:143], v[112:127]
    buffer_load_dwordx4 v249, s[60:63], s89 offen offset:1024 lds
    s_add_u32 s89, s89, 57344
    s_waitcnt vmcnt(14) lgkmcnt(0)
    v_mfma_f32_32x32x16_bf16 v[64:79], v[40:43], v[144:147], v[64:79]
    ds_read_b64_tr_b16 v[32:33], v52 offset:49152
    ds_read_b64_tr_b16 v[34:35], v52 offset:49664
    ds_read_b64_tr_b16 v[36:37], v53 offset:49152
    ds_read_b64_tr_b16 v[38:39], v53 offset:49664
    buffer_load_dwordx4 v[136:139], v58, s[56:59], s90 offen offset:2048 sc1
    v_mfma_f32_32x32x16_bf16 v[80:95], v[40:43], v[148:151], v[80:95]
    buffer_load_dwordx4 v[140:143], v59, s[56:59], s90 offen offset:2048 sc1
    s_add_u32 s90, s90, 4096
    s_add_u32 m0, s87, 90112
    v_mfma_f32_32x32x16_bf16 v[96:111], v[44:47], v[144:147], v[96:111]
    buffer_load_dwordx4 v48, s[60:63], s89 offen lds
    v_mfma_f32_32x32x16_bf16 v[112:127], v[44:47], v[148:151], v[112:127]
    buffer_load_dwordx4 v249, s[60:63], s89 offen offset:1024 lds
    s_add_u32 s89, s89, 57344
    s_waitcnt vmcnt(14) lgkmcnt(0)
    v_mfma_f32_32x32x16_bf16 v[64:79], v[32:35], v[152:155], v[64:79]
    ds_read_b64_tr_b16 v[40:41], v52 offset:57344
    ds_read_b64_tr_b16 v[42:43], v52 offset:57856
    ds_read_b64_tr_b16 v[44:45], v53 offset:57344
    ds_read_b64_tr_b16 v[46:47], v53 offset:57856
    buffer_load_dwordx4 v[144:147], v58, s[56:59], s90 offen offset:0 sc1
    v_mfma_f32_32x32x16_bf16 v[80:95], v[32:35], v[156:159], v[80:95]
    buffer_load_dwordx4 v[148:151], v59, s[56:59], s90 offen offset:0 sc1
    s_add_u32 m0, s87, 0
    v_mfma_f32_32x32x16_bf16 v[96:111], v[36:39], v[152:155], v[96:111]
    buffer_load_dwordx4 v48, s[60:63], s89 offen lds
    v_mfma_f32_32x32x16_bf16 v[112:127], v[36:39], v[156:159], v[112:127]
    buffer_load_dwordx4 v249, s[60:63], s89 offen offset:1024 lds
    s_add_u32 s89, s89, 57344
    s_waitcnt vmcnt(14) lgkmcnt(0)
    v_mfma_f32_32x32x16_bf16 v[64:79], v[40:43], v[160:163], v[64:79]
    ds_read_b64_tr_b16 v[32:33], v240 offset:0
    ds_read_b64_tr_b16 v[34:35], v240 offset:512
    ds_read_b64_tr_b16 v[36:37], v241 offset:0
    ds_read_b64_tr_b16 v[38:39], v241 offset:512
    buffer_load_dwordx4 v[152:155], v58, s[56:59], s90 offen offset:2048 sc1
    v_mfma_f32_32x32x16_bf16 v[80:95], v[40:43], v[164:167], v[80:95]
    buffer_load_dwordx4 v[156:159], v59, s[56:59], s90 offen offset:2048 sc1
    s_add_u32 s90, s90, 4096
    s_add_u32 m0, s87, 8192
    v_mfma_f32_32x32x16_bf16 v[96:111], v[44:47], v[160:163], v[96:111]
    buffer_load_dwordx4 v48, s[60:63], s89 offen lds
    v_mfma_f32_32x32x16_bf16 v[112:127], v[44:47], v[164:167], v[112:127]
    buffer_load_dwordx4 v249, s[60:63], s89 offen offset:1024 lds
    s_add_u32 s89, s89, 57344
    s_waitcnt vmcnt(14) lgkmcnt(0)
    v_mfma_f32_32x32x16_bf16 v[64:79], v[32:35], v[128:131], v[64:79]
    ds_read_b64_tr_b16 v[40:41], v240 offset:8192
    ds_read_b64_tr_b16 v[42:43], v240 offset:8704
    ds_read_b64_tr_b16 v[44:45], v241 offset:8192
    ds_read_b64_tr_b16 v[46:47], v241 offset:8704
    buffer_load_dwordx4 v[160:163], v58, s[56:59], s90 offen offset:0 sc1
    v_mfma_f32_32x32x16_bf16 v[80:95], v[32:35], v[132:135], v[80:95]
    buffer_load_dwordx4 v[164:167], v59, s[56:59], s90 offen offset:0 sc1
    s_add_u32 m0, s87, 16384
    v_mfma_f32_32x32x16_bf16 v[96:111], v[36:39], v[128:131], v[96:111]
    buffer_load_dwordx4 v48, s[60:63], s89 offen lds
    v_mfma_f32_32x32x16_bf16 v[112:127], v[36:39], v[132:135], v[112:127]
    buffer_load_dwordx4 v249, s[60:63], s89 offen offset:1024 lds
    s_add_u32 s89, s89, 57344
    s_waitcnt vmcnt(14) lgkmcnt(0)
    v_mfma_f32_32x32x16_bf16 v[64:79], v[40:43], v[136:139], v[64:79]
    ds_read_b64_tr_b16 v[32:33], v240 offset:16384
    ds_read_b64_tr_b16 v[34:35], v240 offset:16896
    ds_read_b64_tr_b16 v[36:37], v241 offset:16384
    ds_read_b64_tr_b16 v[38:39], v241 offset:16896
    buffer_load_dwordx4 v[128:131], v58, s[56:59], s90 offen offset:2048 sc1
    v_mfma_f32_32x32x16_bf16 v[80:95], v[40:43], v[140:143], v[80:95]
    buffer_load_dwordx4 v[132:135], v59, s[56:59], s90 offen offset:2048 sc1
    s_add_u32 s90, s90, 4096
    s_add_u32 m0, s87, 24576
    v_mfma_f32_32x32x16_bf16 v[96:111], v[44:47], v[136:139], v[96:111]
    buffer_load_dwordx4 v48, s[60:63], s89 offen lds
    v_mfma_f32_32x32x16_bf16 v[112:127], v[44:47], v[140:143], v[112:127]
    buffer_load_dwordx4 v249, s[60:63], s89 offen offset:1024 lds
    s_add_u32 s89, s89, 57344
    s_waitcnt vmcnt(14) lgkmcnt(0)
    v_mfma_f32_32x32x16_bf16 v[64:79], v[32:35], v[144:147], v[64:79]
    ds_read_b64_tr_b16 v[40:41], v240 offset:24576
    ds_read_b64_tr_b16 v[42:43], v240 offset:25088
    ds_read_b64_tr_b16 v[44:45], v241 offset:24576
    ds_read_b64_tr_b16 v[46:47], v241 offset:25088
    buffer_load_dwordx4 v[136:139], v58, s[56:59], s90 offen offset:0 sc1
    v_mfma_f32_32x32x16_bf16 v[80:95], v[32:35], v[148:151], v[80:95]
    buffer_load_dwordx4 v[140:143], v59, s[56:59], s90 offen offset:0 sc1
    s_add_u32 m0, s87, 32768
    v_mfma_f32_32x32x16_bf16 v[96:111], v[36:39], v[144:147], v[96:111]
    buffer_load_dwordx4 v48, s[60:63], s89 offen lds
    v_mfma_f32_32x32x16_bf16 v[112:127], v[36:39], v[148:151], v[112:127]
    buffer_load_dwordx4 v249, s[60:63], s89 offen offset:1024 lds
    s_add_u32 s89, s89, 57344
    s_waitcnt vmcnt(14) lgkmcnt(0)
    v_mfma_f32_32x32x16_bf16 v[64:79], v[40:43], v[152:155], v[64:79]
    ds_read_b64_tr_b16 v[32:33], v52 offset:0
    ds_read_b64_tr_b16 v[34:35], v52 offset:512
    ds_read_b64_tr_b16 v[36:37], v53 offset:0
    ds_read_b64_tr_b16 v[38:39], v53 offset:512
    buffer_load_dwordx4 v[144:147], v58, s[56:59], s90 offen offset:2048 sc1
    v_mfma_f32_32x32x16_bf16 v[80:95], v[40:43], v[156:159], v[80:95]
    buffer_load_dwordx4 v[148:151], v59, s[56:59], s90 offen offset:2048 sc1
    s_add_u32 s90, s90, 4096
    s_add_u32 m0, s87, 40960
    v_mfma_f32_32x32x16_bf16 v[96:111], v[44:47], v[152:155], v[96:111]
    buffer_load_dwordx4 v48, s[60:63], s89 offen lds
    v_mfma_f32_32x32x16_bf16 v[112:127], v[44:47], v[156:159], v[112:127]
    buffer_load_dwordx4 v249, s[60:63], s89 offen offset:1024 lds
    s_add_u32 s89, s89, 57344
    buffer_load_dwordx4 v[200:203], v58, s[56:59], s90 offen offset:0 sc1
    buffer_load_dwordx4 v[204:207], v59, s[56:59], s90 offen offset:0 sc1
    s_waitcnt vmcnt(16) lgkmcnt(0)
    v_mfma_f32_32x32x16_bf16 v[64:79], v[32:35], v[160:163], v[64:79]
    ds_read_b64_tr_b16 v[40:41], v52 offset:8192
    ds_read_b64_tr_b16 v[42:43], v52 offset:8704
    ds_read_b64_tr_b16 v[44:45], v53 offset:8192
    ds_read_b64_tr_b16 v[46:47], v53 offset:8704
    buffer_load_dwordx4 v[208:211], v58, s[56:59], s90 offen offset:2048 sc1
    v_mfma_f32_32x32x16_bf16 v[80:95], v[32:35], v[164:167], v[80:95]
    buffer_load_dwordx4 v[212:215], v59, s[56:59], s90 offen offset:2048 sc1
    s_add_u32 s90, s90, 4096
    s_add_u32 m0, s87, 49152
    v_mfma_f32_32x32x16_bf16 v[96:111], v[36:39], v[160:163], v[96:111]
    buffer_load_dwordx4 v48, s[60:63], s89 offen lds
    v_mfma_f32_32x32x16_bf16 v[112:127], v[36:39], v[164:167], v[112:127]
    buffer_load_dwordx4 v249, s[60:63], s89 offen offset:1024 lds
    s_add_u32 s89, s89, 57344
    buffer_load_dwordx4 v[216:219], v58, s[56:59], s90 offen offset:0 sc1
    buffer_load_dwordx4 v[220:223], v59, s[56:59], s90 offen offset:0 sc1
    s_waitcnt vmcnt(18) lgkmcnt(0)
    v_mfma_f32_32x32x16_bf16 v[64:79], v[40:43], v[128:131], v[64:79]
    ds_read_b64_tr_b16 v[32:33], v52 offset:16384
    ds_read_b64_tr_b16 v[34:35], v52 offset:16896
    ds_read_b64_tr_b16 v[36:37], v53 offset:16384
    ds_read_b64_tr_b16 v[38:39], v53 offset:16896
    buffer_load_dwordx4 v[224:227], v58, s[56:59], s90 offen offset:2048 sc1
    v_mfma_f32_32x32x16_bf16 v[80:95], v[40:43], v[132:135], v[80:95]
    buffer_load_dwordx4 v[228:231], v59, s[56:59], s90 offen offset:2048 sc1
    s_add_u32 s90, s90, 4096
    s_add_u32 m0, s87, 57344
    v_mfma_f32_32x32x16_bf16 v[96:111], v[44:47], v[128:131], v[96:111]
    buffer_load_dwordx4 v48, s[60:63], s89 offen lds
    v_mfma_f32_32x32x16_bf16 v[112:127], v[44:47], v[132:135], v[112:127]
    buffer_load_dwordx4 v249, s[60:63], s89 offen offset:1024 lds
    s_add_u32 s89, s89, 57344
    s_waitcnt vmcnt(18) lgkmcnt(0)
    v_mfma_f32_32x32x16_bf16 v[64:79], v[32:35], v[136:139], v[64:79]
    ds_read_b64_tr_b16 v[40:41], v52 offset:24576
    ds_read_b64_tr_b16 v[42:43], v52 offset:25088
    ds_read_b64_tr_b16 v[44:45], v53 offset:24576
    ds_read_b64_tr_b16 v[46:47], v53 offset:25088
    v_mfma_f32_32x32x16_bf16 v[80:95], v[32:35], v[140:143], v[80:95]
    v_mfma_f32_32x32x16_bf16 v[96:111], v[36:39], v[136:139], v[96:111]
    v_mfma_f32_32x32x16_bf16 v[112:127], v[36:39], v[140:143], v[112:127]
    s_waitcnt vmcnt(0) lgkmcnt(0)
    v_mfma_f32_32x32x16_bf16 v[64:79], v[40:43], v[144:147], v[64:79]
    ds_read_b64_tr_b16 v[168:169], v52 offset:32768
    ds_read_b64_tr_b16 v[170:171], v52 offset:33280
    ds_read_b64_tr_b16 v[172:173], v53 offset:32768
    ds_read_b64_tr_b16 v[174:175], v53 offset:33280
    ds_read_b64_tr_b16 v[176:177], v52 offset:40960
    ds_read_b64_tr_b16 v[178:179], v52 offset:41472
    ds_read_b64_tr_b16 v[180:181], v53 offset:40960
    ds_read_b64_tr_b16 v[182:183], v53 offset:41472
    v_mfma_f32_32x32x16_bf16 v[80:95], v[40:43], v[148:151], v[80:95]
    v_mfma_f32_32x32x16_bf16 v[96:111], v[44:47], v[144:147], v[96:111]
    s_waitcnt lgkmcnt(4)
    ds_read_b64_tr_b16 v[184:185], v52 offset:49152
    ds_read_b64_tr_b16 v[186:187], v52 offset:49664
    ds_read_b64_tr_b16 v[188:189], v53 offset:49152
    ds_read_b64_tr_b16 v[190:191], v53 offset:49664
    ds_read_b64_tr_b16 v[192:193], v52 offset:57344
    ds_read_b64_tr_b16 v[194:195], v52 offset:57856
    ds_read_b64_tr_b16 v[196:197], v53 offset:57344
    ds_read_b64_tr_b16 v[198:199], v53 offset:57856
    v_mfma_f32_32x32x16_bf16 v[112:127], v[44:47], v[148:151], v[112:127]
    s_setprio 3
    s_waitcnt lgkmcnt(0)
    v_mfma_f32_32x32x16_bf16 v[80:95], v[168:171], v[204:207], v[80:95]
    v_mfma_f32_32x32x16_bf16 v[80:95], v[176:179], v[212:215], v[80:95]
    v_mfma_f32_32x32x16_bf16 v[80:95], v[184:187], v[220:223], v[80:95]
    v_mfma_f32_32x32x16_bf16 v[80:95], v[192:195], v[228:231], v[80:95]
    s_add_u32 m0, s87, 65536
    s_nop 0
    buffer_load_dwordx4 v49, s[64:67], s92 offen lds
    buffer_load_dwordx4 v250, s[64:67], s92 offen offset:1024 lds
    s_add_u32 s92, s92, 65536
    s_add_u32 m0, s87, 73728
    s_nop 0
    buffer_load_dwordx4 v49, s[64:67], s92 offen lds
    buffer_load_dwordx4 v250, s[64:67], s92 offen offset:1024 lds
    s_add_u32 s92, s92, 65536
    s_cmp_eq_u32 s92, s37
    s_cselect_b32 s92, s36, s92
    s_add_u32 m0, s87, 81920
    s_nop 0
    buffer_load_dwordx4 v49, s[64:67], s92 offen lds
    buffer_load_dwordx4 v250, s[64:67], s92 offen offset:1024 lds
    s_add_u32 s92, s92, 65536
    s_add_u32 m0, s87, 90112
    s_nop 0
    buffer_load_dwordx4 v49, s[64:67], s92 offen lds
    buffer_load_dwordx4 v250, s[64:67], s92 offen offset:1024 lds
    s_add_u32 s92, s92, 65536
    s_cmp_eq_u32 s92, s37
    s_cselect_b32 s92, s36, s92
    v_mfma_f32_32x32x16_bf16 v[96:111], v[172:175], v[200:203], v[96:111]
    v_mfma_f32_32x32x16_bf16 v[96:111], v[180:183], v[208:211], v[96:111]
    s_nop 9
    ds_write_b128 v24, v[80:83] offset:0
    ds_write_b128 v24, v[84:87] offset:1024
    v_mfma_f32_32x32x16_bf16 v[96:111], v[188:191], v[216:219], v[96:111]
    ds_write_b128 v24, v[88:91] offset:2048
    ds_write_b128 v24, v[92:95] offset:3072
    v_mfma_f32_32x32x16_bf16 v[96:111], v[196:199], v[224:227], v[96:111]
    v_mfma_f32_32x32x16_bf16 v[112:127], v[172:175], v[204:207], v[112:127]
    v_mfma_f32_32x32x16_bf16 v[112:127], v[180:183], v[212:215], v[112:127]
    s_nop 9
    ds_write_b128 v24, v[96:99] offset:4096
    ds_write_b128 v24, v[100:103] offset:5120
    v_mfma_f32_32x32x16_bf16 v[112:127], v[188:191], v[220:223], v[112:127]
    ds_write_b128 v24, v[104:107] offset:6144
    ds_write_b128 v24, v[108:111] offset:7168
    v_mfma_f32_32x32x16_bf16 v[112:127], v[196:199], v[228:231], v[112:127]
    v_mfma_f32_32x32x16_bf16 v[64:79], v[168:171], v[200:203], v[64:79]
    v_mfma_f32_32x32x16_bf16 v[64:79], v[176:179], v[208:211], v[64:79]
    s_nop 9
    ds_write_b128 v24, v[112:115] offset:8192
    ds_write_b128 v24, v[116:119] offset:9216
    v_mfma_f32_32x32x16_bf16 v[64:79], v[184:187], v[216:219], v[64:79]
    ds_write_b128 v24, v[120:123] offset:10240
    ds_write_b128 v24, v[124:127] offset:11264
    s_mov_b64 exec, 1
    ds_add_u32 v0, v29 offset:24
    s_mov_b64 exec, -1
    v_mfma_f32_32x32x16_bf16 v[64:79], v[192:195], v[224:227], v[64:79]
    s_setprio 3
    s_add_u32 m0, s87, 0
    s_nop 0
    buffer_load_dwordx4 v49, s[64:67], s92 offen lds
    buffer_load_dwordx4 v250, s[64:67], s92 offen offset:1024 lds
    s_add_u32 s92, s92, 65536
    s_add_u32 m0, s87, 8192
    s_nop 0
    buffer_load_dwordx4 v49, s[64:67], s92 offen lds
    buffer_load_dwordx4 v250, s[64:67], s92 offen offset:1024 lds
    s_add_u32 s92, s92, 65536
    s_cmp_eq_u32 s92, s37
    s_cselect_b32 s92, s36, s92
    s_add_u32 m0, s87, 16384
    s_nop 0
    buffer_load_dwordx4 v49, s[64:67], s92 offen lds
    buffer_load_dwordx4 v250, s[64:67], s92 offen offset:1024 lds
    s_add_u32 s92, s92, 65536
    s_add_u32 m0, s87, 24576
    s_nop 0
    buffer_load_dwordx4 v49, s[64:67], s92 offen lds
    buffer_load_dwordx4 v250, s[64:67], s92 offen offset:1024 lds
    s_add_u32 s92, s92, 65536
    s_cmp_eq_u32 s92, s37
    s_cselect_b32 s92, s36, s92
    s_branch spe_83
spin_82:
    s_sleep 1
spe_83:
    ds_read_b32 v28, v0 offset:24
    s_waitcnt lgkmcnt(0)
    v_readfirstlane_b32 s13, v28
    s_cmp_lt_u32 s13, 4
    s_cbranch_scc1 spin_82
    ds_read_b128 v[80:83], v25 offset:0
    ds_read_b128 v[84:87], v25 offset:1024
    ds_read_b128 v[88:91], v25 offset:2048
    ds_read_b128 v[92:95], v25 offset:3072
    ds_read_b128 v[96:99], v26 offset:4096
    ds_read_b128 v[100:103], v26 offset:5120
    ds_read_b128 v[104:107], v26 offset:6144
    ds_read_b128 v[108:111], v26 offset:7168
    ds_read_b128 v[112:115], v27 offset:8192
    ds_read_b128 v[116:119], v27 offset:9216
    ds_read_b128 v[120:123], v27 offset:10240
    ds_read_b128 v[124:127], v27 offset:11264
    s_add_u32 m0, s87, 32768
    s_nop 0
    buffer_load_dwordx4 v49, s[64:67], s92 offen lds
    buffer_load_dwordx4 v250, s[64:67], s92 offen offset:1024 lds
    s_add_u32 s92, s92, 65536
    s_add_u32 m0, s87, 40960
    s_nop 0
    buffer_load_dwordx4 v49, s[64:67], s92 offen lds
    buffer_load_dwordx4 v250, s[64:67], s92 offen offset:1024 lds
    s_add_u32 s92, s92, 65536
    s_cmp_eq_u32 s92, s37
    s_cselect_b32 s92, s36, s92
    s_add_u32 m0, s87, 49152
    s_nop 0
    buffer_load_dwordx4 v49, s[64:67], s92 offen lds
    buffer_load_dwordx4 v250, s[64:67], s92 offen offset:1024 lds
    s_add_u32 s92, s92, 65536
    s_waitcnt lgkmcnt(8)
    v_add_f32 v64, v64, v80
    v_add_f32 v65, v65, v81
    v_add_f32 v66, v66, v82
    v_add_f32 v67, v67, v83
    v_add_f32 v68, v68, v84
    v_add_f32 v69, v69, v85
    v_add_f32 v70, v70, v86
    v_add_f32 v71, v71, v87
    v_add_f32 v72, v72, v88
    v_add_f32 v73, v73, v89
    v_add_f32 v74, v74, v90
    v_add_f32 v75, v75, v91
    v_add_f32 v76, v76, v92
    v_add_f32 v77, v77, v93
    v_add_f32 v78, v78, v94
    v_add_f32 v79, v79, v95
    s_waitcnt lgkmcnt(4)
    v_add_f32 v64, v64, v96
    v_add_f32 v65, v65, v97
    v_add_f32 v66, v66, v98
    v_add_f32 v67, v67, v99
    v_add_f32 v68, v68, v100
    v_add_f32 v69, v69, v101
    v_add_f32 v70, v70, v102
    v_add_f32 v71, v71, v103
    v_add_f32 v72, v72, v104
    v_add_f32 v73, v73, v105
    v_add_f32 v74, v74, v106
    v_add_f32 v75, v75, v107
    v_add_f32 v76, v76, v108
    v_add_f32 v77, v77, v109
    v_add_f32 v78, v78, v110
    v_add_f32 v79, v79, v111
    s_waitcnt lgkmcnt(0)
    v_add_f32 v64, v64, v112
    v_add_f32 v65, v65, v113
    v_add_f32 v66, v66, v114
    v_add_f32 v67, v67, v115
    v_add_f32 v68, v68, v116
    v_add_f32 v69, v69, v117
    v_add_f32 v70, v70, v118
    v_add_f32 v71, v71, v119
    v_add_f32 v72, v72, v120
    v_add_f32 v73, v73, v121
    v_add_f32 v74, v74, v122
    v_add_f32 v75, v75, v123
    v_add_f32 v76, v76, v124
    v_add_f32 v77, v77, v125
    v_add_f32 v78, v78, v126
    v_add_f32 v79, v79, v127
    s_mov_b64 exec, 1
    ds_add_u32 v0, v29 offset:28
    s_mov_b64 exec, -1
    s_mov_b32 s8, 0xbdd2d3e8
    v_mul_f32 v80, v64, v64
    v_mul_f32 v81, v65, v65
    v_mul_f32 v82, v66, v66
    v_mul_f32 v83, v67, v67
    v_mul_f32 v84, v68, v68
    v_mul_f32 v85, v69, v69
    v_mul_f32 v86, v70, v70
    v_mul_f32 v87, v71, v71
    v_fma_f32 v80, v80, s8, v7
    v_fma_f32 v81, v81, s8, v7
    v_fma_f32 v82, v82, s8, v7
    v_fma_f32 v83, v83, s8, v7
    v_fma_f32 v84, v84, s8, v7
    v_fma_f32 v85, v85, s8, v7
    v_fma_f32 v86, v86, s8, v7
    v_fma_f32 v87, v87, s8, v7
    v_mul_f32 v80, v80, v64
    v_mul_f32 v81, v81, v65
    v_mul_f32 v82, v82, v66
    v_mul_f32 v83, v83, v67
    v_mul_f32 v84, v84, v68
    v_mul_f32 v85, v85, v69
    v_mul_f32 v86, v86, v70
    v_mul_f32 v87, v87, v71
    v_exp_f32 v80, v80
    v_exp_f32 v81, v81
    v_exp_f32 v82, v82
    v_exp_f32 v83, v83
    v_exp_f32 v84, v84
    v_exp_f32 v85, v85
    v_exp_f32 v86, v86
    v_exp_f32 v87, v87
    v_add_f32 v80, 1.0, v80
    v_add_f32 v81, 1.0, v81
    v_add_f32 v82, 1.0, v82
    v_add_f32 v83, 1.0, v83
    v_add_f32 v84, 1.0, v84
    v_add_f32 v85, 1.0, v85
    v_add_f32 v86, 1.0, v86
    v_add_f32 v87, 1.0, v87
    v_rcp_f32 v80, v80
    v_rcp_f32 v81, v81
    v_rcp_f32 v82, v82
    v_rcp_f32 v83, v83
    v_rcp_f32 v84, v84
    v_rcp_f32 v85, v85
    v_rcp_f32 v86, v86
    v_rcp_f32 v87, v87
    v_mul_f32 v80, v80, v64
    v_mul_f32 v81, v81, v65
    v_mul_f32 v82, v82, v66
    v_mul_f32 v83, v83, v67
    v_mul_f32 v84, v84, v68
    v_mul_f32 v85, v85, v69
    v_mul_f32 v86, v86, v70
    v_mul_f32 v87, v87, v71
    v_cvt_pk_bf16_f32 v96, v80, v81
    v_cvt_pk_bf16_f32 v97, v82, v83
    v_cvt_pk_bf16_f32 v98, v84, v85
    v_cvt_pk_bf16_f32 v99, v86, v87
    buffer_store_dwordx4 v[96:99], v58, s[56:59], s30 offen offset:0 sc1
    v_mul_f32 v88, v72, v72
    v_mul_f32 v89, v73, v73
    v_mul_f32 v90, v74, v74
    v_mul_f32 v91, v75, v75
    v_mul_f32 v92, v76, v76
    v_mul_f32 v93, v77, v77
    v_mul_f32 v94, v78, v78
    v_mul_f32 v95, v79, v79
    v_fma_f32 v88, v88, s8, v7
    v_fma_f32 v89, v89, s8, v7
    v_fma_f32 v90, v90, s8, v7
    v_fma_f32 v91, v91, s8, v7
    v_fma_f32 v92, v92, s8, v7
    v_fma_f32 v93, v93, s8, v7
    v_fma_f32 v94, v94, s8, v7
    v_fma_f32 v95, v95, s8, v7
    v_mul_f32 v88, v88, v72
    v_mul_f32 v89, v89, v73
    v_mul_f32 v90, v90, v74
    v_mul_f32 v91, v91, v75
    v_mul_f32 v92, v92, v76
    v_mul_f32 v93, v93, v77
    v_mul_f32 v94, v94, v78
    v_mul_f32 v95, v95, v79
    v_exp_f32 v88, v88
    v_exp_f32 v89, v89
    v_exp_f32 v90, v90
    v_exp_f32 v91, v91
    v_exp_f32 v92, v92
    v_exp_f32 v93, v93
    v_exp_f32 v94, v94
    v_exp_f32 v95, v95
    v_add_f32 v88, 1.0, v88
    v_add_f32 v89, 1.0, v89
    v_add_f32 v90, 1.0, v90
    v_add_f32 v91, 1.0, v91
    v_add_f32 v92, 1.0, v92
    v_add_f32 v93, 1.0, v93
    v_add_f32 v94, 1.0, v94
    v_add_f32 v95, 1.0, v95
    v_rcp_f32 v88, v88
    v_rcp_f32 v89, v89
    v_rcp_f32 v90, v90
    v_rcp_f32 v91, v91
    v_rcp_f32 v92, v92
    v_rcp_f32 v93, v93
    v_rcp_f32 v94, v94
    v_rcp_f32 v95, v95
    v_mul_f32 v88, v88, v72
    v_mul_f32 v89, v89, v73
    v_mul_f32 v90, v90, v74
    v_mul_f32 v91, v91, v75
    v_mul_f32 v92, v92, v76
    v_mul_f32 v93, v93, v77
    v_mul_f32 v94, v94, v78
    v_mul_f32 v95, v95, v79
    v_cvt_pk_bf16_f32 v100, v88, v89
    v_cvt_pk_bf16_f32 v101, v90, v91
    v_cvt_pk_bf16_f32 v102, v92, v93
    v_cvt_pk_bf16_f32 v103, v94, v95
    buffer_store_dwordx4 v[100:103], v58, s[56:59], s30 offen offset:2048 sc1
    v_mov_b32 v30, s42
    v_mov_b32 v31, s43
    s_waitcnt vmcnt(0)
    s_mov_b64 exec, 1
    buffer_store_dwordx2 v[30:31], off, s[56:59], s29 sc1
    s_mov_b64 exec, -1
    s_branch gjoin_72
nog1_71:
    s_setprio 3
    v_lshrrev_b32 v36, 2, v1
    v_and_b32 v37, 3, v1
    v_lshlrev_b32 v37, 5, v37
    v_lshl_add_u32 v37, v36, 7, v37
    v_lshlrev_b32 v38, 1, v1
    v_and_b32 v38, 16, v38
    v_add_u32 v37, v37, v38
    s_lshl_b32 s8, s84, 11
    v_add_u32 v37, s8, v37
    v_xor_b32 v39, 16, v37
    s_lshl_b32 s8, s84, 7
    s_add_u32 s8, s8, 158720
    v_lshl_add_u32 v36, v36, 3, s8
    v_mov_b32 v40, 0
    v_mov_b32 v41, 0
    s_branch spe_85
spin_84:
    s_sleep 1
spe_85:
    ds_read_b32 v28, v0 offset:40
    s_waitcnt lgkmcnt(0)
    v_readfirstlane_b32 s13, v28
    s_cmp_lt_u32 s13, 4
    s_cbranch_scc1 spin_84
    s_branch spe_87
spin_86:
    s_sleep 1
spe_87:
    ds_read_b32 v28, v0 offset:44
    s_waitcnt lgkmcnt(0)
    v_readfirstlane_b32 s13, v28
    s_cmp_lt_u32 s13, 4
    s_cbranch_scc1 spin_86
    ds_read_b128 v[128:131], v37 offset:0
    ds_read_b128 v[132:135], v39 offset:0
    ds_read_b128 v[136:139], v37 offset:8192
    ds_read_b128 v[140:143], v39 offset:8192
    ds_read_b128 v[144:147], v37 offset:16384
    ds_read_b128 v[148:151], v39 offset:16384
    ds_read_b128 v[152:155], v37 offset:24576
    ds_read_b128 v[156:159], v39 offset:24576
    ds_read_b128 v[160:163], v37 offset:32768
    ds_read_b128 v[164:167], v39 offset:32768
    ds_read_b128 v[168:171], v37 offset:40960
    ds_read_b128 v[172:175], v39 offset:40960
    ds_read_b128 v[176:179], v37 offset:49152
    ds_read_b128 v[180:183], v39 offset:49152
    s_waitcnt lgkmcnt(12)
    v_dot2c_f32_bf16 v40, s82, v128
    v_dot2c_f32_bf16 v41, v128, v128
    v_dot2c_f32_bf16 v40, s82, v129
    v_dot2c_f32_bf16 v41, v129, v129
    v_dot2c_f32_bf16 v40, s82, v130
    v_dot2c_f32_bf16 v41, v130, v130
    v_dot2c_f32_bf16 v40, s82, v131
    v_dot2c_f32_bf16 v41, v131, v131
    v_dot2c_f32_bf16 v40, s82, v132
    v_dot2c_f32_bf16 v41, v132, v132
    v_dot2c_f32_bf16 v40, s82, v133
    v_dot2c_f32_bf16 v41, v133, v133
    v_dot2c_f32_bf16 v40, s82, v134
    v_dot2c_f32_bf16 v41, v134, v134
    v_dot2c_f32_bf16 v40, s82, v135
    v_dot2c_f32_bf16 v41, v135, v135
    s_waitcnt lgkmcnt(10)
    v_dot2c_f32_bf16 v40, s82, v136
    v_dot2c_f32_bf16 v41, v136, v136
    v_dot2c_f32_bf16 v40, s82, v137
    v_dot2c_f32_bf16 v41, v137, v137
    v_dot2c_f32_bf16 v40, s82, v138
    v_dot2c_f32_bf16 v41, v138, v138
    v_dot2c_f32_bf16 v40, s82, v139
    v_dot2c_f32_bf16 v41, v139, v139
    v_dot2c_f32_bf16 v40, s82, v140
    v_dot2c_f32_bf16 v41, v140, v140
    v_dot2c_f32_bf16 v40, s82, v141
    v_dot2c_f32_bf16 v41, v141, v141
    v_dot2c_f32_bf16 v40, s82, v142
    v_dot2c_f32_bf16 v41, v142, v142
    v_dot2c_f32_bf16 v40, s82, v143
    v_dot2c_f32_bf16 v41, v143, v143
    s_waitcnt lgkmcnt(8)
    v_dot2c_f32_bf16 v40, s82, v144
    v_dot2c_f32_bf16 v41, v144, v144
    v_dot2c_f32_bf16 v40, s82, v145
    v_dot2c_f32_bf16 v41, v145, v145
    v_dot2c_f32_bf16 v40, s82, v146
    v_dot2c_f32_bf16 v41, v146, v146
    v_dot2c_f32_bf16 v40, s82, v147
    v_dot2c_f32_bf16 v41, v147, v147
    v_dot2c_f32_bf16 v40, s82, v148
    v_dot2c_f32_bf16 v41, v148, v148
    v_dot2c_f32_bf16 v40, s82, v149
    v_dot2c_f32_bf16 v41, v149, v149
    v_dot2c_f32_bf16 v40, s82, v150
    v_dot2c_f32_bf16 v41, v150, v150
    v_dot2c_f32_bf16 v40, s82, v151
    v_dot2c_f32_bf16 v41, v151, v151
    s_waitcnt lgkmcnt(6)
    v_dot2c_f32_bf16 v40, s82, v152
    v_dot2c_f32_bf16 v41, v152, v152
    v_dot2c_f32_bf16 v40, s82, v153
    v_dot2c_f32_bf16 v41, v153, v153
    v_dot2c_f32_bf16 v40, s82, v154
    v_dot2c_f32_bf16 v41, v154, v154
    v_dot2c_f32_bf16 v40, s82, v155
    v_dot2c_f32_bf16 v41, v155, v155
    v_dot2c_f32_bf16 v40, s82, v156
    v_dot2c_f32_bf16 v41, v156, v156
    v_dot2c_f32_bf16 v40, s82, v157
    v_dot2c_f32_bf16 v41, v157, v157
    v_dot2c_f32_bf16 v40, s82, v158
    v_dot2c_f32_bf16 v41, v158, v158
    v_dot2c_f32_bf16 v40, s82, v159
    v_dot2c_f32_bf16 v41, v159, v159
    s_waitcnt lgkmcnt(4)
    v_dot2c_f32_bf16 v40, s82, v160
    v_dot2c_f32_bf16 v41, v160, v160
    v_dot2c_f32_bf16 v40, s82, v161
    v_dot2c_f32_bf16 v41, v161, v161
    v_dot2c_f32_bf16 v40, s82, v162
    v_dot2c_f32_bf16 v41, v162, v162
    v_dot2c_f32_bf16 v40, s82, v163
    v_dot2c_f32_bf16 v41, v163, v163
    v_dot2c_f32_bf16 v40, s82, v164
    v_dot2c_f32_bf16 v41, v164, v164
    v_dot2c_f32_bf16 v40, s82, v165
    v_dot2c_f32_bf16 v41, v165, v165
    v_dot2c_f32_bf16 v40, s82, v166
    v_dot2c_f32_bf16 v41, v166, v166
    v_dot2c_f32_bf16 v40, s82, v167
    v_dot2c_f32_bf16 v41, v167, v167
    s_waitcnt lgkmcnt(2)
    v_dot2c_f32_bf16 v40, s82, v168
    v_dot2c_f32_bf16 v41, v168, v168
    v_dot2c_f32_bf16 v40, s82, v169
    v_dot2c_f32_bf16 v41, v169, v169
    v_dot2c_f32_bf16 v40, s82, v170
    v_dot2c_f32_bf16 v41, v170, v170
    v_dot2c_f32_bf16 v40, s82, v171
    v_dot2c_f32_bf16 v41, v171, v171
    v_dot2c_f32_bf16 v40, s82, v172
    v_dot2c_f32_bf16 v41, v172, v172
    v_dot2c_f32_bf16 v40, s82, v173
    v_dot2c_f32_bf16 v41, v173, v173
    v_dot2c_f32_bf16 v40, s82, v174
    v_dot2c_f32_bf16 v41, v174, v174
    v_dot2c_f32_bf16 v40, s82, v175
    v_dot2c_f32_bf16 v41, v175, v175
    s_waitcnt lgkmcnt(0)
    v_dot2c_f32_bf16 v40, s82, v176
    v_dot2c_f32_bf16 v41, v176, v176
    v_dot2c_f32_bf16 v40, s82, v177
    v_dot2c_f32_bf16 v41, v177, v177
    v_dot2c_f32_bf16 v40, s82, v178
    v_dot2c_f32_bf16 v41, v178, v178
    v_dot2c_f32_bf16 v40, s82, v179
    v_dot2c_f32_bf16 v41, v179, v179
    v_dot2c_f32_bf16 v40, s82, v180
    v_dot2c_f32_bf16 v41, v180, v180
    v_dot2c_f32_bf16 v40, s82, v181
    v_dot2c_f32_bf16 v41, v181, v181
    v_dot2c_f32_bf16 v40, s82, v182
    v_dot2c_f32_bf16 v41, v182, v182
    v_dot2c_f32_bf16 v40, s82, v183
    v_dot2c_f32_bf16 v41, v183, v183
    s_nop 2
    v_add_f32_dpp v40, v40, v40 quad_perm:[1,0,3,2] row_mask:0xf bank_mask:0xf
    v_add_f32_dpp v41, v41, v41 quad_perm:[1,0,3,2] row_mask:0xf bank_mask:0xf
    s_nop 0
    v_add_f32_dpp v40, v40, v40 quad_perm:[2,3,0,1] row_mask:0xf bank_mask:0xf
    v_add_f32_dpp v41, v41, v41 quad_perm:[2,3,0,1] row_mask:0xf bank_mask:0xf
    s_nop 0
    v_mul_f32 v40, 0x3b124925, v40
    v_mul_f32 v41, 0x3b124925, v41
    v_fma_f32 v41, -v40, v40, v41
    v_max_f32 v41, 0, v41
    v_cvt_pk_bf16_f32 v38, v40, v41
    v_lshlrev_b32 v39, 16, v38
    v_and_b32 v38, 0xffff0000, v38
    v_add_f32 v38, 0x3727c5ac, v38
    v_cvt_pk_bf16_f32 v38, v38, v38
    v_and_b32 v38, 0xffff0000, v38
    v_sqrt_f32 v38, v38
    s_nop 0
    v_cvt_pk_bf16_f32 v38, v38, v38
    v_and_b32 v38, 0xffff0000, v38
    v_rcp_f32 v43, v38
    s_nop 0
    v_cvt_pk_bf16_f32 v42, -v39, -v39
    v_mul_f32 v43, 0x3e8b97f6, v43
    ds_write_b64 v36, v[42:43]
    s_mov_b64 exec, 1
    ds_add_u32 v0, v29 offset:12
    s_mov_b64 exec, -1
    s_setprio 0
    s_mov_b64 exec, 1
    ds_add_u32 v0, v29 offset:28
    s_mov_b64 exec, -1
    s_mov_b64 exec, 1
    ds_add_u32 v0, v29 offset:60
    s_mov_b64 exec, -1
    s_mov_b64 exec, 1
    ds_add_u32 v0, v29 offset:52
    s_mov_b64 exec, -1
    s_mov_b32 s64, s32
    s_mov_b32 s65, s33
    s_mov_b32 s66, 7340032
    s_mov_b32 s67, 0x20000
    s_mov_b32 s68, s24
    s_mov_b32 s69, s25
    s_mov_b32 s70, 401408
    s_mov_b32 s71, 0x20000
    s_mov_b32 s72, s36
    s_mov_b32 s73, s37
    s_mov_b32 s74, 1835008
    s_mov_b32 s75, 0x20000
    s_mov_b32 s20, s34
    s_mov_b32 s21, s35
    s_mov_b32 s22, 4096
    s_mov_b32 s23, 0x20000
    s_mul_i32 s92, s84, 1835008
    s_lshl_b32 s8, s5, 7
    s_add_u32 s92, s92, s8
    s_mul_i32 s93, s84, 100352
    s_lshl_b32 s8, s6, 7
    s_add_u32 s93, s93, s8
    s_lshl_b32 s8, s85, 6
    s_lshl_b32 s9, s86, 6
    v_lshl_add_u32 v24, v3, 9, v56
    v_xor_b32 v54, s9, v24
    v_xor_b32 v55, 64, v54
    v_xor_b32 v56, s8, v24
    v_xor_b32 v57, 64, v56
    s_lshl_b32 s8, s85, 10
    v_add_u32 v60, s8, v4
    v_xor_b32 v61, 0x400, v60
    s_mul_i32 s94, s6, 112
    s_mul_i32 s8, s84, 28
    s_add_u32 s94, s94, s8
    s_lshl_b32 s94, s94, 11
    s_add_u32 s94, s94, 5242880
    s_lshr_b32 s8, s4, 3
    s_add_u32 s8, s8, 3
    s_lshl_b32 s8, s8, 13
    s_add_u32 s32, s8, s94
    s_lshl_b32 s95, s5, 16
    s_lshl_b32 s8, s84, 14
    s_add_u32 s95, s95, s8
    s_add_u32 s95, s95, 7340032
    v_mul_u32_u24 v51, 896, v2
    v_lshl_add_u32 v51, v3, 4, v51
    s_lshl_b32 s8, s5, 1
    s_add_u32 s8, s8, s86
    s_lshl_b32 s97, s8, 6
    s_mul_i32 s8, s8, 28672
    s_lshl_b32 s9, s6, 7
    s_add_u32 s8, s8, s9
    s_lshl_b32 s9, s85, 6
    s_add_u32 s96, s8, s9
    v_lshrrev_b32 v63, 2, v1
    v_and_b32 v24, 3, v1
    v_lshlrev_b32 v63, 12, v63
    v_lshl_add_u32 v63, v24, 7, v63
    s_mul_i32 s8, s88, 112
    s_lshl_b32 s9, s91, 2
    s_add_u32 s8, s8, s9
    s_lshl_b32 s10, s85, 1
    s_add_u32 s8, s8, s10
    s_lshl_b32 s8, s8, 11
    s_add_u32 s30, s8, 5242880
    s_lshl_b32 s8, s88, 7
    s_add_u32 s8, s8, s9
    s_add_u32 s8, s8, s84
    s_lshl_b32 s8, s8, 3
    s_lshl_b32 s8, s8, 3
    s_add_u32 s29, s8, 10682368
    s_lshl_b32 s8, s6, 10
    s_mul_i32 s9, s84, 224
    s_add_u32 s8, s8, s9
    s_lshl_b32 s8, s8, 3
    s_add_u32 s31, s8, 10682368
    s_lshl_b32 s8, s5, 8
    s_lshl_b32 s9, s84, 6
    s_add_u32 s8, s8, s9
    s_lshl_b32 s8, s8, 3
    s_add_u32 s33, s8, 10813440
    v_add_u32 v242, 0x10000, v54
    v_add_u32 v243, 0x10000, v55
    v_add_u32 v244, 0x10000, v56
    v_add_u32 v245, 0x10000, v57
    s_lshr_b32 s8, s4, 3
    s_mul_i32 s8, s8, 0
    s_mul_i32 s9, s3, 4
    s_add_u32 s8, s8, s9
    s_mul_i32 s9, s8, 2341
    s_lshr_b32 s9, s9, 16
    s_mul_i32 s9, s9, 28
    s_sub_u32 s8, s8, s9
    s_mov_b32 s34, s94
    s_add_u32 s35, s94, 57344
    s_mov_b32 s36, s92
    s_add_u32 s37, s92, 1835008
    s_lshl_b32 s9, s8, 11
    s_add_u32 s94, s94, s9
    s_lshl_b32 s9, s8, 16
    s_add_u32 s92, s92, s9
    v_lshlrev_b32 v6, 1, v2
    buffer_load_ushort v5, v6, s[20:23], s97 offen
    s_waitcnt vmcnt(0) lgkmcnt(0)
    v_lshlrev_b32 v5, 16, v5
    v_lshlrev_b32 v8, 16, v80
    v_and_b32 v9, 0xffff0000, v80
    v_lshlrev_b32 v10, 16, v81
    v_and_b32 v11, 0xffff0000, v81
    v_lshlrev_b32 v12, 16, v82
    v_and_b32 v13, 0xffff0000, v82
    v_lshlrev_b32 v14, 16, v83
    v_and_b32 v15, 0xffff0000, v83
    v_lshlrev_b32 v16, 16, v84
    v_and_b32 v17, 0xffff0000, v84
    v_lshlrev_b32 v18, 16, v85
    v_and_b32 v19, 0xffff0000, v85
    v_lshlrev_b32 v20, 16, v86
    v_and_b32 v21, 0xffff0000, v86
    v_lshlrev_b32 v22, 16, v87
    v_and_b32 v23, 0xffff0000, v87
    v_add_f32 v8, v5, v8
    v_add_f32 v9, v5, v9
    v_add_f32 v10, v5, v10
    v_add_f32 v11, v5, v11
    v_add_f32 v12, v5, v12
    v_add_f32 v13, v5, v13
    v_add_f32 v14, v5, v14
    v_add_f32 v15, v5, v15
    v_add_f32 v16, v5, v16
    v_add_f32 v17, v5, v17
    v_add_f32 v18, v5, v18
    v_add_f32 v19, v5, v19
    v_add_f32 v20, v5, v20
    v_add_f32 v21, v5, v21
    v_add_f32 v22, v5, v22
    v_add_f32 v23, v5, v23
    v_min_u32 v251, 27, v1
    v_lshlrev_b32 v251, 6, v251
    v_min_u32 v252, 7, v1
    v_lshlrev_b32 v252, 6, v252
    s_lshr_b32 s8, s4, 3
    s_lshl_b32 s8, s8, 1
    s_and_b32 s9, s6, 1
    s_add_u32 s8, s8, s9
    s_sub_u32 s8, s8, 1
    s_cmp_eq_u32 s4, 6
    s_cbranch_scc1 engdone
    s_mul_i32 s9, s84, 28
    s_add_u32 s9, s9, s8
    s_lshl_b32 s9, s9, 16
    s_lshl_b32 s10, s3, 9
    s_add_u32 s9, s9, s10
    s_lshl_b32 s10, s8, 2
    s_add_u32 s10, s10, s84
    s_lshl_b32 s10, s10, 13
    s_add_u32 s99, s99, 200704
    s_branch spe_89
spin_88:
    s_sleep 1
spe_89:
    ds_read_b32 v28, v0 offset:0
    s_waitcnt lgkmcnt(0)
    v_readfirstlane_b32 s13, v28
    s_cmp_lt_u32 s13, 4
    s_cbranch_scc1 spin_88
    s_waitcnt vmcnt(0)
    buffer_load_dword v249, v246, s[60:63], s99 offen
    s_add_u32 s99, s99, 200704
    s_waitcnt vmcnt(0)
    buffer_load_dword v250, v246, s[60:63], s99 offen
    s_add_u32 s99, s99, 200704
    s_waitcnt vmcnt(0)
    buffer_load_dword v249, v246, s[60:63], s99 offen
    s_add_u32 s99, s99, 200704
    s_waitcnt vmcnt(0)
    buffer_load_dword v250, v246, s[60:63], s99 offen
    s_add_u32 s99, s99, 200704
    s_waitcnt vmcnt(0)
    buffer_load_dword v249, v246, s[60:63], s99 offen
    s_add_u32 s99, s99, 200704
    s_waitcnt vmcnt(0)
    buffer_load_dword v250, v246, s[60:63], s99 offen
    s_add_u32 s99, s99, 200704
    s_waitcnt vmcnt(0)
    buffer_load_dword v249, v246, s[60:63], s99 offen
    s_add_u32 s99, s99, 200704
    s_waitcnt vmcnt(0)
    buffer_load_dword v250, v246, s[60:63], s99 offen
    s_add_u32 s99, s99, 200704
    s_waitcnt vmcnt(0)
    buffer_load_dword v249, v246, s[60:63], s99 offen
    s_add_u32 s99, s99, 200704
    s_waitcnt vmcnt(0)
    buffer_load_dword v249, v63, s[64:67], s9 offen
    s_add_u32 s9, s9, 458752
    s_waitcnt vmcnt(0)
    buffer_load_dword v250, v63, s[64:67], s9 offen
    s_add_u32 s9, s9, 458752
    s_waitcnt vmcnt(0)
    buffer_load_dword v249, v63, s[64:67], s9 offen
    s_add_u32 s9, s9, 458752
    s_waitcnt vmcnt(0)
    buffer_load_dword v250, v63, s[64:67], s9 offen
    s_add_u32 s9, s9, 458752
    s_cmp_lg_u32 s6, 7
    s_cbranch_scc1 engdone
    s_lshr_b32 s10, s4, 3
    s_lshl_b32 s10, s10, 2
    s_add_u32 s10, s10, s84
    s_lshl_b32 s10, s10, 13
    s_waitcnt vmcnt(0)
    buffer_load_dword v249, v62, s[68:71], s10 offen
    s_add_u32 s10, s10, 131072
    s_waitcnt vmcnt(0)
    buffer_load_dword v250, v62, s[68:71], s10 offen
    s_add_u32 s10, s10, 131072
    s_waitcnt vmcnt(0)
    buffer_load_dword v249, v62, s[68:71], s10 offen
    s_add_u32 s10, s10, 131072
    s_waitcnt vmcnt(0)
    buffer_load_dword v250, v62, s[68:71], s10 offen
    s_add_u32 s10, s10, 131072
    s_branch epw
engdone:
    s_waitcnt vmcnt(0)
    s_setprio 3
    v_add_u32 v249, 27648, v48
    v_add_u32 v250, 31744, v49
    s_branch spe_91
spin_90:
    s_sleep 1
spe_91:
    ds_read_b32 v28, v0 offset:16
    s_waitcnt lgkmcnt(0)
    v_readfirstlane_b32 s13, v28
    s_cmp_lt_u32 s13, 4
    s_cbranch_scc1 spin_90
    s_add_u32 m0, s87, 65536
    s_nop 0
    buffer_load_dwordx4 v49, s[64:67], s92 offen lds
    buffer_load_dwordx4 v250, s[64:67], s92 offen offset:1024 lds
    s_add_u32 s92, s92, 65536
    s_add_u32 m0, s87, 73728
    s_nop 0
    buffer_load_dwordx4 v49, s[64:67], s92 offen lds
    buffer_load_dwordx4 v250, s[64:67], s92 offen offset:1024 lds
    s_add_u32 s92, s92, 65536
    s_cmp_eq_u32 s92, s37
    s_cselect_b32 s92, s36, s92
    s_add_u32 m0, s87, 81920
    s_nop 0
    buffer_load_dwordx4 v49, s[64:67], s92 offen lds
    buffer_load_dwordx4 v250, s[64:67], s92 offen offset:1024 lds
    s_add_u32 s92, s92, 65536
    s_add_u32 m0, s87, 90112
    s_nop 0
    buffer_load_dwordx4 v49, s[64:67], s92 offen lds
    buffer_load_dwordx4 v250, s[64:67], s92 offen offset:1024 lds
    s_add_u32 s92, s92, 65536
    s_cmp_eq_u32 s92, s37
    s_cselect_b32 s92, s36, s92
    s_add_u32 m0, s87, 0
    s_nop 0
    buffer_load_dwordx4 v49, s[64:67], s92 offen lds
    buffer_load_dwordx4 v250, s[64:67], s92 offen offset:1024 lds
    s_add_u32 s92, s92, 65536
    s_add_u32 m0, s87, 8192
    s_nop 0
    buffer_load_dwordx4 v49, s[64:67], s92 offen lds
    buffer_load_dwordx4 v250, s[64:67], s92 offen offset:1024 lds
    s_add_u32 s92, s92, 65536
    s_cmp_eq_u32 s92, s37
    s_cselect_b32 s92, s36, s92
    s_add_u32 m0, s87, 16384
    s_nop 0
    buffer_load_dwordx4 v49, s[64:67], s92 offen lds
    buffer_load_dwordx4 v250, s[64:67], s92 offen offset:1024 lds
    s_add_u32 s92, s92, 65536
    s_add_u32 m0, s87, 24576
    s_nop 0
    buffer_load_dwordx4 v49, s[64:67], s92 offen lds
    buffer_load_dwordx4 v250, s[64:67], s92 offen offset:1024 lds
    s_add_u32 s92, s92, 65536
    s_cmp_eq_u32 s92, s37
    s_cselect_b32 s92, s36, s92
    s_add_u32 m0, s87, 32768
    s_nop 0
    buffer_load_dwordx4 v49, s[64:67], s92 offen lds
    buffer_load_dwordx4 v250, s[64:67], s92 offen offset:1024 lds
    s_add_u32 s92, s92, 65536
    s_add_u32 m0, s87, 40960
    s_nop 0
    buffer_load_dwordx4 v49, s[64:67], s92 offen lds
    buffer_load_dwordx4 v250, s[64:67], s92 offen offset:1024 lds
    s_add_u32 s92, s92, 65536
    s_cmp_eq_u32 s92, s37
    s_cselect_b32 s92, s36, s92
    s_add_u32 m0, s87, 49152
    s_nop 0
    buffer_load_dwordx4 v49, s[64:67], s92 offen lds
    buffer_load_dwordx4 v250, s[64:67], s92 offen offset:1024 lds
    s_add_u32 s92, s92, 65536
gjoin_72:
    s_setprio 0
    s_add_u32 m0, s87, 57344
    s_nop 0
    buffer_load_dwordx4 v49, s[64:67], s92 offen lds
    buffer_load_dwordx4 v250, s[64:67], s92 offen offset:1024 lds
    s_add_u32 s92, s92, 65536
    s_cmp_eq_u32 s92, s37
    s_cselect_b32 s92, s36, s92
    buffer_load_dwordx4 v[168:171], v49, s[64:67], s92 offen
    s_add_u32 s92, s92, 32768
    buffer_load_dwordx4 v[172:175], v49, s[64:67], s92 offen
    s_add_u32 s92, s92, 32768
    buffer_load_dwordx4 v[176:179], v49, s[64:67], s92 offen
    s_add_u32 s92, s92, 32768
    buffer_load_dwordx4 v[180:183], v49, s[64:67], s92 offen
    s_add_u32 s92, s92, 32768
    s_cmp_eq_u32 s92, s37
    s_cselect_b32 s92, s36, s92
    buffer_load_dwordx4 v[184:187], v49, s[64:67], s92 offen
    s_add_u32 s92, s92, 32768
    buffer_load_dwordx4 v[188:191], v49, s[64:67], s92 offen
    s_add_u32 s92, s92, 32768
    buffer_load_dwordx4 v[192:195], v49, s[64:67], s92 offen
    s_add_u32 s92, s92, 32768
    buffer_load_dwordx4 v[196:199], v49, s[64:67], s92 offen
    s_add_u32 s92, s92, 32768
    s_cmp_eq_u32 s92, s37
    s_cselect_b32 s92, s36, s92
    buffer_load_dwordx4 v[200:203], v49, s[64:67], s92 offen
    s_add_u32 s92, s92, 32768
    buffer_load_dwordx4 v[204:207], v49, s[64:67], s92 offen
    s_add_u32 s92, s92, 32768
    buffer_load_dwordx4 v[208:211], v49, s[64:67], s92 offen
    s_add_u32 s92, s92, 32768
    buffer_load_dwordx4 v[212:215], v49, s[64:67], s92 offen
    s_add_u32 s92, s92, 32768
    s_cmp_eq_u32 s92, s37
    s_cselect_b32 s92, s36, s92
    buffer_load_dwordx4 v[216:219], v49, s[64:67], s92 offen
    s_add_u32 s92, s92, 32768
    buffer_load_dwordx4 v[220:223], v49, s[64:67], s92 offen
    s_add_u32 s92, s92, 32768
    buffer_load_dwordx4 v[224:227], v49, s[64:67], s92 offen
    s_add_u32 s92, s92, 32768
    buffer_load_dwordx4 v[228:231], v49, s[64:67], s92 offen
    s_add_u32 s92, s92, 32768
    s_cmp_eq_u32 s92, s37
    s_cselect_b32 s92, s36, s92
    buffer_load_dwordx4 v[232:235], v49, s[64:67], s92 offen
    s_add_u32 s92, s92, 32768
    buffer_load_dwordx4 v[236:239], v49, s[64:67], s92 offen
    s_add_u32 s92, s92, 32768
    buffer_load_dwordx2 v[30:31], v251, s[56:59], s31 offen sc1
    s_waitcnt vmcnt(0)
    s_setprio 3
    v_cmp_ne_u64 vcc, s[42:43], v[30:31]
    s_setprio 0
    s_cbranch_vccz flok_92
    s_setprio 3
    v_min_u32 v28, 27, v1
    v_lshlrev_b32 v28, 6, v28
    s_mov_b32 s83, 20000
poll_93:
    buffer_load_dwordx2 v[30:31], v28, s[56:59], s31 offen sc1
    s_waitcnt vmcnt(0)
    v_cmp_ne_u64 vcc, s[42:43], v[30:31]
    s_cbranch_vccz polld_94
    s_sub_u32 s83, s83, 1
    s_cmp_lg_u32 s83, 0
    s_cbranch_scc1 poll_93
polld_94:
    s_setprio 0
flok_92:
    buffer_load_dwordx4 v[144:147], v60, s[56:59], s94 offen offset:0 sc1
    buffer_load_dwordx4 v[148:151], v61, s[56:59], s94 offen offset:0 sc1
    buffer_load_dwordx4 v[152:155], v60, s[56:59], s94 offen offset:2048 sc1
    buffer_load_dwordx4 v[156:159], v61, s[56:59], s94 offen offset:2048 sc1
    s_add_u32 s94, s94, 4096
    s_cmp_eq_u32 s94, s35
    s_cselect_b32 s94, s34, s94
    buffer_load_dwordx4 v[160:163], v60, s[56:59], s94 offen offset:0 sc1
    buffer_load_dwordx4 v[164:167], v61, s[56:59], s94 offen offset:0 sc1
    buffer_load_dwordx4 v[128:131], v60, s[56:59], s94 offen offset:2048 sc1
    buffer_load_dwordx4 v[132:135], v61, s[56:59], s94 offen offset:2048 sc1
    s_add_u32 s94, s94, 4096
    s_cmp_eq_u32 s94, s35
    s_cselect_b32 s94, s34, s94
    ds_read_b64_tr_b16 v[32:33], v242 offset:0
    ds_read_b64_tr_b16 v[34:35], v242 offset:1024
    ds_read_b64_tr_b16 v[36:37], v243 offset:0
    ds_read_b64_tr_b16 v[38:39], v243 offset:1024
    s_setprio 0
    s_lshr_b32 s81, s4, 3
    s_waitcnt vmcnt(6) lgkmcnt(0)
    v_mfma_f32_32x32x16_bf16 v[64:79], v[144:147], v[32:35], v[8:23]
    ds_read_b64_tr_b16 v[40:41], v242 offset:8192
    ds_read_b64_tr_b16 v[42:43], v242 offset:9216
    ds_read_b64_tr_b16 v[44:45], v243 offset:8192
    ds_read_b64_tr_b16 v[46:47], v243 offset:9216
    buffer_load_dwordx4 v[136:139], v60, s[56:59], s94 offen offset:0 sc1
    v_mfma_f32_32x32x16_bf16 v[80:95], v[144:147], v[36:39], 0
    buffer_load_dwordx4 v[140:143], v61, s[56:59], s94 offen offset:0 sc1
    v_mfma_f32_32x32x16_bf16 v[96:111], v[148:151], v[32:35], 0
    v_mfma_f32_32x32x16_bf16 v[112:127], v[148:151], v[36:39], 0
    s_waitcnt vmcnt(6) lgkmcnt(0)
    v_mfma_f32_32x32x16_bf16 v[64:79], v[152:155], v[40:43], v[64:79]
    ds_read_b64_tr_b16 v[32:33], v242 offset:16384
    ds_read_b64_tr_b16 v[34:35], v242 offset:17408
    ds_read_b64_tr_b16 v[36:37], v243 offset:16384
    ds_read_b64_tr_b16 v[38:39], v243 offset:17408
    buffer_load_dwordx4 v[144:147], v60, s[56:59], s94 offen offset:2048 sc1
    v_mfma_f32_32x32x16_bf16 v[80:95], v[152:155], v[44:47], v[80:95]
    buffer_load_dwordx4 v[148:151], v61, s[56:59], s94 offen offset:2048 sc1
    s_add_u32 s94, s94, 4096
    s_cmp_eq_u32 s94, s35
    s_cselect_b32 s94, s34, s94
    v_mfma_f32_32x32x16_bf16 v[96:111], v[156:159], v[40:43], v[96:111]
    v_mfma_f32_32x32x16_bf16 v[112:127], v[156:159], v[44:47], v[112:127]
    s_waitcnt vmcnt(6) lgkmcnt(0)
    v_mfma_f32_32x32x16_bf16 v[64:79], v[160:163], v[32:35], v[64:79]
    ds_read_b64_tr_b16 v[40:41], v242 offset:24576
    ds_read_b64_tr_b16 v[42:43], v242 offset:25600
    ds_read_b64_tr_b16 v[44:45], v243 offset:24576
    ds_read_b64_tr_b16 v[46:47], v243 offset:25600
    buffer_load_dwordx4 v[152:155], v60, s[56:59], s94 offen offset:0 sc1
    v_mfma_f32_32x32x16_bf16 v[80:95], v[160:163], v[36:39], v[80:95]
    buffer_load_dwordx4 v[156:159], v61, s[56:59], s94 offen offset:0 sc1
    v_mfma_f32_32x32x16_bf16 v[96:111], v[164:167], v[32:35], v[96:111]
    v_mfma_f32_32x32x16_bf16 v[112:127], v[164:167], v[36:39], v[112:127]
    s_waitcnt vmcnt(6) lgkmcnt(0)
    v_mfma_f32_32x32x16_bf16 v[64:79], v[128:131], v[40:43], v[64:79]
    ds_read_b64_tr_b16 v[32:33], v54 offset:0
    ds_read_b64_tr_b16 v[34:35], v54 offset:1024
    ds_read_b64_tr_b16 v[36:37], v55 offset:0
    ds_read_b64_tr_b16 v[38:39], v55 offset:1024
    buffer_load_dwordx4 v[160:163], v60, s[56:59], s94 offen offset:2048 sc1
    v_mfma_f32_32x32x16_bf16 v[80:95], v[128:131], v[44:47], v[80:95]
    buffer_load_dwordx4 v[164:167], v61, s[56:59], s94 offen offset:2048 sc1
    s_add_u32 s94, s94, 4096
    s_cmp_eq_u32 s94, s35
    s_cselect_b32 s94, s34, s94
    v_mfma_f32_32x32x16_bf16 v[96:111], v[132:135], v[40:43], v[96:111]
    v_mfma_f32_32x32x16_bf16 v[112:127], v[132:135], v[44:47], v[112:127]
    s_waitcnt vmcnt(6) lgkmcnt(0)
    v_mfma_f32_32x32x16_bf16 v[64:79], v[136:139], v[32:35], v[64:79]
    ds_read_b64_tr_b16 v[40:41], v54 offset:8192
    ds_read_b64_tr_b16 v[42:43], v54 offset:9216
    ds_read_b64_tr_b16 v[44:45], v55 offset:8192
    ds_read_b64_tr_b16 v[46:47], v55 offset:9216
    buffer_load_dwordx4 v[128:131], v60, s[56:59], s94 offen offset:0 sc1
    v_mfma_f32_32x32x16_bf16 v[80:95], v[136:139], v[36:39], v[80:95]
    buffer_load_dwordx4 v[132:135], v61, s[56:59], s94 offen offset:0 sc1
    v_mfma_f32_32x32x16_bf16 v[96:111], v[140:143], v[32:35], v[96:111]
    v_mfma_f32_32x32x16_bf16 v[112:127], v[140:143], v[36:39], v[112:127]
    s_waitcnt vmcnt(6) lgkmcnt(0)
    v_mfma_f32_32x32x16_bf16 v[64:79], v[144:147], v[40:43], v[64:79]
    ds_read_b64_tr_b16 v[32:33], v54 offset:16384
    ds_read_b64_tr_b16 v[34:35], v54 offset:17408
    ds_read_b64_tr_b16 v[36:37], v55 offset:16384
    ds_read_b64_tr_b16 v[38:39], v55 offset:17408
    buffer_load_dwordx4 v[136:139], v60, s[56:59], s94 offen offset:2048 sc1
    v_mfma_f32_32x32x16_bf16 v[80:95], v[144:147], v[44:47], v[80:95]
    buffer_load_dwordx4 v[140:143], v61, s[56:59], s94 offen offset:2048 sc1
    s_add_u32 s94, s94, 4096
    s_cmp_eq_u32 s94, s35
    s_cselect_b32 s94, s34, s94
    v_mfma_f32_32x32x16_bf16 v[96:111], v[148:151], v[40:43], v[96:111]
    v_mfma_f32_32x32x16_bf16 v[112:127], v[148:151], v[44:47], v[112:127]
    s_waitcnt vmcnt(6) lgkmcnt(0)
    v_mfma_f32_32x32x16_bf16 v[64:79], v[152:155], v[32:35], v[64:79]
    ds_read_b64_tr_b16 v[40:41], v54 offset:24576
    ds_read_b64_tr_b16 v[42:43], v54 offset:25600
    ds_read_b64_tr_b16 v[44:45], v55 offset:24576
    ds_read_b64_tr_b16 v[46:47], v55 offset:25600
    buffer_load_dwordx4 v[144:147], v60, s[56:59], s94 offen offset:0 sc1
    v_mfma_f32_32x32x16_bf16 v[80:95], v[152:155], v[36:39], v[80:95]
    buffer_load_dwordx4 v[148:151], v61, s[56:59], s94 offen offset:0 sc1
    v_mfma_f32_32x32x16_bf16 v[96:111], v[156:159], v[32:35], v[96:111]
    v_mfma_f32_32x32x16_bf16 v[112:127], v[156:159], v[36:39], v[112:127]
    s_waitcnt vmcnt(6) lgkmcnt(0)
    v_mfma_f32_32x32x16_bf16 v[64:79], v[160:163], v[40:43], v[64:79]
    ds_read_b64_tr_b16 v[32:33], v54 offset:32768
    ds_read_b64_tr_b16 v[34:35], v54 offset:33792
    ds_read_b64_tr_b16 v[36:37], v55 offset:32768
    ds_read_b64_tr_b16 v[38:39], v55 offset:33792
    buffer_load_dwordx4 v[152:155], v60, s[56:59], s94 offen offset:2048 sc1
    v_mfma_f32_32x32x16_bf16 v[80:95], v[160:163], v[44:47], v[80:95]
    buffer_load_dwordx4 v[156:159], v61, s[56:59], s94 offen offset:2048 sc1
    s_add_u32 s94, s94, 4096
    s_cmp_eq_u32 s94, s35
    s_cselect_b32 s94, s34, s94
    v_mfma_f32_32x32x16_bf16 v[96:111], v[164:167], v[40:43], v[96:111]
    v_mfma_f32_32x32x16_bf16 v[112:127], v[164:167], v[44:47], v[112:127]
    s_waitcnt vmcnt(6) lgkmcnt(0)
    v_mfma_f32_32x32x16_bf16 v[64:79], v[128:131], v[32:35], v[64:79]
    ds_read_b64_tr_b16 v[40:41], v54 offset:40960
    ds_read_b64_tr_b16 v[42:43], v54 offset:41984
    ds_read_b64_tr_b16 v[44:45], v55 offset:40960
    ds_read_b64_tr_b16 v[46:47], v55 offset:41984
    buffer_load_dwordx4 v[160:163], v60, s[56:59], s94 offen offset:0 sc1
    v_mfma_f32_32x32x16_bf16 v[80:95], v[128:131], v[36:39], v[80:95]
    buffer_load_dwordx4 v[164:167], v61, s[56:59], s94 offen offset:0 sc1
    v_mfma_f32_32x32x16_bf16 v[96:111], v[132:135], v[32:35], v[96:111]
    v_mfma_f32_32x32x16_bf16 v[112:127], v[132:135], v[36:39], v[112:127]
    s_waitcnt vmcnt(6) lgkmcnt(0)
    v_mfma_f32_32x32x16_bf16 v[64:79], v[136:139], v[40:43], v[64:79]
    ds_read_b64_tr_b16 v[32:33], v54 offset:49152
    ds_read_b64_tr_b16 v[34:35], v54 offset:50176
    ds_read_b64_tr_b16 v[36:37], v55 offset:49152
    ds_read_b64_tr_b16 v[38:39], v55 offset:50176
    buffer_load_dwordx4 v[128:131], v60, s[56:59], s94 offen offset:2048 sc1
    v_mfma_f32_32x32x16_bf16 v[80:95], v[136:139], v[44:47], v[80:95]
    buffer_load_dwordx4 v[132:135], v61, s[56:59], s94 offen offset:2048 sc1
    s_add_u32 s94, s94, 4096
    s_cmp_eq_u32 s94, s35
    s_cselect_b32 s94, s34, s94
    v_mfma_f32_32x32x16_bf16 v[96:111], v[140:143], v[40:43], v[96:111]
    ds_write_b128 v248, v[168:171] offset:0
    ds_write_b128 v248, v[172:175] offset:1024
    v_mfma_f32_32x32x16_bf16 v[112:127], v[140:143], v[44:47], v[112:127]
    s_waitcnt vmcnt(6) lgkmcnt(0)
    v_mfma_f32_32x32x16_bf16 v[64:79], v[144:147], v[32:35], v[64:79]
    ds_read_b64_tr_b16 v[40:41], v54 offset:57344
    ds_read_b64_tr_b16 v[42:43], v54 offset:58368
    ds_read_b64_tr_b16 v[44:45], v55 offset:57344
    ds_read_b64_tr_b16 v[46:47], v55 offset:58368
    buffer_load_dwordx4 v[136:139], v60, s[56:59], s94 offen offset:0 sc1
    v_mfma_f32_32x32x16_bf16 v[80:95], v[144:147], v[36:39], v[80:95]
    buffer_load_dwordx4 v[140:143], v61, s[56:59], s94 offen offset:0 sc1
    s_add_u32 m0, s87, 40960
    v_mfma_f32_32x32x16_bf16 v[96:111], v[148:151], v[32:35], v[96:111]
    buffer_load_dwordx4 v49, s[64:67], s92 offen lds
    ds_write_b128 v248, v[176:179] offset:8192
    ds_write_b128 v248, v[180:183] offset:9216
    v_mfma_f32_32x32x16_bf16 v[112:127], v[148:151], v[36:39], v[112:127]
    buffer_load_dwordx4 v250, s[64:67], s92 offen offset:1024 lds
    s_add_u32 s92, s92, 65536
    s_cmp_eq_u32 s92, s37
    s_cselect_b32 s92, s36, s92
    s_waitcnt vmcnt(8) lgkmcnt(0)
    v_mfma_f32_32x32x16_bf16 v[64:79], v[152:155], v[40:43], v[64:79]
    ds_read_b64_tr_b16 v[32:33], v242 offset:0
    ds_read_b64_tr_b16 v[34:35], v242 offset:1024
    ds_read_b64_tr_b16 v[36:37], v243 offset:0
    ds_read_b64_tr_b16 v[38:39], v243 offset:1024
    buffer_load_dwordx4 v[144:147], v60, s[56:59], s94 offen offset:2048 sc1
    v_mfma_f32_32x32x16_bf16 v[80:95], v[152:155], v[44:47], v[80:95]
    buffer_load_dwordx4 v[148:151], v61, s[56:59], s94 offen offset:2048 sc1
    s_add_u32 s94, s94, 4096
    s_cmp_eq_u32 s94, s35
    s_cselect_b32 s94, s34, s94
    s_add_u32 m0, s87, 49152
    v_mfma_f32_32x32x16_bf16 v[96:111], v[156:159], v[40:43], v[96:111]
    buffer_load_dwordx4 v49, s[64:67], s92 offen lds
    ds_write_b128 v248, v[184:187] offset:16384
    ds_write_b128 v248, v[188:191] offset:17408
    v_mfma_f32_32x32x16_bf16 v[112:127], v[156:159], v[44:47], v[112:127]
    buffer_load_dwordx4 v250, s[64:67], s92 offen offset:1024 lds
    s_add_u32 s92, s92, 65536
    s_waitcnt vmcnt(10) lgkmcnt(0)
    v_mfma_f32_32x32x16_bf16 v[64:79], v[160:163], v[32:35], v[64:79]
    ds_read_b64_tr_b16 v[40:41], v242 offset:8192
    ds_read_b64_tr_b16 v[42:43], v242 offset:9216
    ds_read_b64_tr_b16 v[44:45], v243 offset:8192
    ds_read_b64_tr_b16 v[46:47], v243 offset:9216
    buffer_load_dwordx4 v[152:155], v60, s[56:59], s94 offen offset:0 sc1
    v_mfma_f32_32x32x16_bf16 v[80:95], v[160:163], v[36:39], v[80:95]
    buffer_load_dwordx4 v[156:159], v61, s[56:59], s94 offen offset:0 sc1
    s_add_u32 m0, s87, 57344
    v_mfma_f32_32x32x16_bf16 v[96:111], v[164:167], v[32:35], v[96:111]
    buffer_load_dwordx4 v49, s[64:67], s92 offen lds
    ds_write_b128 v248, v[192:195] offset:24576
    ds_write_b128 v248, v[196:199] offset:25600
    v_mfma_f32_32x32x16_bf16 v[112:127], v[164:167], v[36:39], v[112:127]
    buffer_load_dwordx4 v250, s[64:67], s92 offen offset:1024 lds
    s_add_u32 s92, s92, 65536
    s_cmp_eq_u32 s92, s37
    s_cselect_b32 s92, s36, s92
    s_waitcnt vmcnt(12) lgkmcnt(0)
    v_mfma_f32_32x32x16_bf16 v[64:79], v[128:131], v[40:43], v[64:79]
    ds_read_b64_tr_b16 v[32:33], v242 offset:16384
    ds_read_b64_tr_b16 v[34:35], v242 offset:17408
    ds_read_b64_tr_b16 v[36:37], v243 offset:16384
    ds_read_b64_tr_b16 v[38:39], v243 offset:17408
    buffer_load_dwordx4 v[160:163], v60, s[56:59], s94 offen offset:2048 sc1
    v_mfma_f32_32x32x16_bf16 v[80:95], v[128:131], v[44:47], v[80:95]
    buffer_load_dwordx4 v[164:167], v61, s[56:59], s94 offen offset:2048 sc1
    s_add_u32 s94, s94, 4096
    s_cmp_eq_u32 s94, s35
    s_cselect_b32 s94, s34, s94
    s_add_u32 m0, s87, 65536
    v_mfma_f32_32x32x16_bf16 v[96:111], v[132:135], v[40:43], v[96:111]
    buffer_load_dwordx4 v49, s[64:67], s92 offen lds
    ds_write_b128 v247, v[200:203] offset:0
    ds_write_b128 v247, v[204:207] offset:1024
    v_mfma_f32_32x32x16_bf16 v[112:127], v[132:135], v[44:47], v[112:127]
    buffer_load_dwordx4 v250, s[64:67], s92 offen offset:1024 lds
    s_add_u32 s92, s92, 65536
    s_waitcnt vmcnt(14) lgkmcnt(0)
    v_mfma_f32_32x32x16_bf16 v[64:79], v[136:139], v[32:35], v[64:79]
    ds_read_b64_tr_b16 v[40:41], v242 offset:24576
    ds_read_b64_tr_b16 v[42:43], v242 offset:25600
    ds_read_b64_tr_b16 v[44:45], v243 offset:24576
    ds_read_b64_tr_b16 v[46:47], v243 offset:25600
    buffer_load_dwordx4 v[128:131], v60, s[56:59], s94 offen offset:0 sc1
    v_mfma_f32_32x32x16_bf16 v[80:95], v[136:139], v[36:39], v[80:95]
    buffer_load_dwordx4 v[132:135], v61, s[56:59], s94 offen offset:0 sc1
    s_add_u32 m0, s87, 73728
    v_mfma_f32_32x32x16_bf16 v[96:111], v[140:143], v[32:35], v[96:111]
    buffer_load_dwordx4 v49, s[64:67], s92 offen lds
    ds_write_b128 v247, v[208:211] offset:8192
    ds_write_b128 v247, v[212:215] offset:9216
    v_mfma_f32_32x32x16_bf16 v[112:127], v[140:143], v[36:39], v[112:127]
    buffer_load_dwordx4 v250, s[64:67], s92 offen offset:1024 lds
    s_add_u32 s92, s92, 65536
    s_cmp_eq_u32 s92, s37
    s_cselect_b32 s92, s36, s92
    s_waitcnt vmcnt(14) lgkmcnt(0)
    v_mfma_f32_32x32x16_bf16 v[64:79], v[144:147], v[40:43], v[64:79]
    ds_read_b64_tr_b16 v[32:33], v54 offset:0
    ds_read_b64_tr_b16 v[34:35], v54 offset:1024
    ds_read_b64_tr_b16 v[36:37], v55 offset:0
    ds_read_b64_tr_b16 v[38:39], v55 offset:1024
    buffer_load_dwordx4 v[136:139], v60, s[56:59], s94 offen offset:2048 sc1
    v_mfma_f32_32x32x16_bf16 v[80:95], v[144:147], v[44:47], v[80:95]
    buffer_load_dwordx4 v[140:143], v61, s[56:59], s94 offen offset:2048 sc1
    s_add_u32 s94, s94, 4096
    s_cmp_eq_u32 s94, s35
    s_cselect_b32 s94, s34, s94
    s_add_u32 m0, s87, 81920
    v_mfma_f32_32x32x16_bf16 v[96:111], v[148:151], v[40:43], v[96:111]
    buffer_load_dwordx4 v49, s[64:67], s92 offen lds
    ds_write_b128 v247, v[216:219] offset:16384
    ds_write_b128 v247, v[220:223] offset:17408
    v_mfma_f32_32x32x16_bf16 v[112:127], v[148:151], v[44:47], v[112:127]
    buffer_load_dwordx4 v250, s[64:67], s92 offen offset:1024 lds
    s_add_u32 s92, s92, 65536
    s_waitcnt vmcnt(14) lgkmcnt(0)
    v_mfma_f32_32x32x16_bf16 v[64:79], v[152:155], v[32:35], v[64:79]
    ds_read_b64_tr_b16 v[40:41], v54 offset:8192
    ds_read_b64_tr_b16 v[42:43], v54 offset:9216
    ds_read_b64_tr_b16 v[44:45], v55 offset:8192
    ds_read_b64_tr_b16 v[46:47], v55 offset:9216
    buffer_load_dwordx4 v[144:147], v60, s[56:59], s94 offen offset:0 sc1
    v_mfma_f32_32x32x16_bf16 v[80:95], v[152:155], v[36:39], v[80:95]
    buffer_load_dwordx4 v[148:151], v61, s[56:59], s94 offen offset:0 sc1
    s_add_u32 m0, s87, 90112
    v_mfma_f32_32x32x16_bf16 v[96:111], v[156:159], v[32:35], v[96:111]
    buffer_load_dwordx4 v49, s[64:67], s92 offen lds
    ds_write_b128 v247, v[224:227] offset:24576
    ds_write_b128 v247, v[228:231] offset:25600
    v_mfma_f32_32x32x16_bf16 v[112:127], v[156:159], v[36:39], v[112:127]
    buffer_load_dwordx4 v250, s[64:67], s92 offen offset:1024 lds
    s_add_u32 s92, s92, 65536
    s_cmp_eq_u32 s92, s37
    s_cselect_b32 s92, s36, s92
    s_waitcnt vmcnt(14) lgkmcnt(0)
    v_mfma_f32_32x32x16_bf16 v[64:79], v[160:163], v[40:43], v[64:79]
    ds_read_b64_tr_b16 v[32:33], v54 offset:16384
    ds_read_b64_tr_b16 v[34:35], v54 offset:17408
    ds_read_b64_tr_b16 v[36:37], v55 offset:16384
    ds_read_b64_tr_b16 v[38:39], v55 offset:17408
    buffer_load_dwordx4 v[152:155], v60, s[56:59], s94 offen offset:2048 sc1
    v_mfma_f32_32x32x16_bf16 v[80:95], v[160:163], v[44:47], v[80:95]
    buffer_load_dwordx4 v[156:159], v61, s[56:59], s94 offen offset:2048 sc1
    s_add_u32 s94, s94, 4096
    s_cmp_eq_u32 s94, s35
    s_cselect_b32 s94, s34, s94
    s_add_u32 m0, s87, 0
    v_mfma_f32_32x32x16_bf16 v[96:111], v[164:167], v[40:43], v[96:111]
    buffer_load_dwordx4 v50, s[68:71], s93 offen lds
    s_add_u32 s93, s93, 7168
    s_add_u32 m0, s87, 1024
    ds_write_b128 v247, v[232:235] offset:32768
    ds_write_b128 v247, v[236:239] offset:33792
    v_mfma_f32_32x32x16_bf16 v[112:127], v[164:167], v[44:47], v[112:127]
    buffer_load_dwordx4 v50, s[68:71], s93 offen lds
    s_add_u32 s93, s93, 7168
    s_waitcnt vmcnt(14) lgkmcnt(0)
    v_mfma_f32_32x32x16_bf16 v[64:79], v[128:131], v[32:35], v[64:79]
    ds_read_b64_tr_b16 v[40:41], v54 offset:24576
    ds_read_b64_tr_b16 v[42:43], v54 offset:25600
    ds_read_b64_tr_b16 v[44:45], v55 offset:24576
    ds_read_b64_tr_b16 v[46:47], v55 offset:25600
    buffer_load_dwordx4 v[160:163], v60, s[56:59], s94 offen offset:0 sc1
    v_mfma_f32_32x32x16_bf16 v[80:95], v[128:131], v[36:39], v[80:95]
    buffer_load_dwordx4 v[164:167], v61, s[56:59], s94 offen offset:0 sc1
    s_add_u32 m0, s87, 8192
    v_mfma_f32_32x32x16_bf16 v[96:111], v[132:135], v[32:35], v[96:111]
    buffer_load_dwordx4 v50, s[68:71], s93 offen lds
    s_add_u32 s93, s93, 7168
    s_add_u32 m0, s87, 9216
    v_mfma_f32_32x32x16_bf16 v[112:127], v[132:135], v[36:39], v[112:127]
    buffer_load_dwordx4 v50, s[68:71], s93 offen lds
    s_add_u32 s93, s93, 3584
    s_waitcnt vmcnt(14) lgkmcnt(0)
    v_mfma_f32_32x32x16_bf16 v[64:79], v[136:139], v[40:43], v[64:79]
    ds_read_b64_tr_b16 v[32:33], v54 offset:32768
    ds_read_b64_tr_b16 v[34:35], v54 offset:33792
    ds_read_b64_tr_b16 v[36:37], v55 offset:32768
    ds_read_b64_tr_b16 v[38:39], v55 offset:33792
    buffer_load_dwordx4 v[128:131], v60, s[56:59], s94 offen offset:2048 sc1
    v_mfma_f32_32x32x16_bf16 v[80:95], v[136:139], v[44:47], v[80:95]
    buffer_load_dwordx4 v[132:135], v61, s[56:59], s94 offen offset:2048 sc1
    s_add_u32 s94, s94, 4096
    s_cmp_eq_u32 s94, s35
    s_cselect_b32 s94, s34, s94
    s_add_u32 m0, s87, 16384
    v_mfma_f32_32x32x16_bf16 v[96:111], v[140:143], v[40:43], v[96:111]
    buffer_load_dwordx4 v50, s[68:71], s93 offen lds
    s_add_u32 s93, s93, 7168
    s_add_u32 m0, s87, 17408
    v_mfma_f32_32x32x16_bf16 v[112:127], v[140:143], v[44:47], v[112:127]
    buffer_load_dwordx4 v50, s[68:71], s93 offen lds
    s_add_u32 s93, s93, 7168
    s_waitcnt vmcnt(14) lgkmcnt(0)
    v_mfma_f32_32x32x16_bf16 v[64:79], v[144:147], v[32:35], v[64:79]
    ds_read_b64_tr_b16 v[40:41], v54 offset:40960
    ds_read_b64_tr_b16 v[42:43], v54 offset:41984
    ds_read_b64_tr_b16 v[44:45], v55 offset:40960
    ds_read_b64_tr_b16 v[46:47], v55 offset:41984
    buffer_load_dwordx4 v[136:139], v60, s[56:59], s94 offen offset:0 sc1
    v_mfma_f32_32x32x16_bf16 v[80:95], v[144:147], v[36:39], v[80:95]
    buffer_load_dwordx4 v[140:143], v61, s[56:59], s94 offen offset:0 sc1
    s_add_u32 m0, s87, 24576
    v_mfma_f32_32x32x16_bf16 v[96:111], v[148:151], v[32:35], v[96:111]
    buffer_load_dwordx4 v50, s[68:71], s93 offen lds
    s_add_u32 s93, s93, 7168
    s_add_u32 m0, s87, 25600
    v_mfma_f32_32x32x16_bf16 v[112:127], v[148:151], v[36:39], v[112:127]
    buffer_load_dwordx4 v50, s[68:71], s93 offen lds
    s_add_u32 s93, s93, 3584
    s_waitcnt vmcnt(14) lgkmcnt(0)
    v_mfma_f32_32x32x16_bf16 v[64:79], v[152:155], v[40:43], v[64:79]
    ds_read_b64_tr_b16 v[32:33], v54 offset:49152
    ds_read_b64_tr_b16 v[34:35], v54 offset:50176
    ds_read_b64_tr_b16 v[36:37], v55 offset:49152
    ds_read_b64_tr_b16 v[38:39], v55 offset:50176
    buffer_load_dwordx4 v[144:147], v60, s[56:59], s94 offen offset:2048 sc1
    v_mfma_f32_32x32x16_bf16 v[80:95], v[152:155], v[44:47], v[80:95]
    buffer_load_dwordx4 v[148:151], v61, s[56:59], s94 offen offset:2048 sc1
    s_add_u32 s94, s94, 4096
    s_cmp_eq_u32 s94, s35
    s_cselect_b32 s94, s34, s94
    s_add_u32 m0, s87, 32768
    v_mfma_f32_32x32x16_bf16 v[96:111], v[156:159], v[40:43], v[96:111]
    buffer_load_dwordx4 v50, s[68:71], s93 offen lds
    s_add_u32 s93, s93, 7168
    s_add_u32 m0, s87, 33792
    v_mfma_f32_32x32x16_bf16 v[112:127], v[156:159], v[44:47], v[112:127]
    buffer_load_dwordx4 v50, s[68:71], s93 offen lds
    s_add_u32 s93, s93, 7168
    s_waitcnt vmcnt(14) lgkmcnt(0)
    v_mfma_f32_32x32x16_bf16 v[64:79], v[160:163], v[32:35], v[64:79]
    ds_read_b64_tr_b16 v[40:41], v54 offset:57344
    ds_read_b64_tr_b16 v[42:43], v54 offset:58368
    ds_read_b64_tr_b16 v[44:45], v55 offset:57344
    ds_read_b64_tr_b16 v[46:47], v55 offset:58368
    buffer_load_dwordx4 v[152:155], v60, s[56:59], s94 offen offset:0 sc1
    v_mfma_f32_32x32x16_bf16 v[80:95], v[160:163], v[36:39], v[80:95]
    buffer_load_dwordx4 v[156:159], v61, s[56:59], s94 offen offset:0 sc1
    s_add_u32 m0, s87, 40960
    v_mfma_f32_32x32x16_bf16 v[96:111], v[164:167], v[32:35], v[96:111]
    buffer_load_dwordx4 v50, s[68:71], s93 offen lds
    s_add_u32 s93, s93, 7168
    s_add_u32 m0, s87, 41984
    v_mfma_f32_32x32x16_bf16 v[112:127], v[164:167], v[36:39], v[112:127]
    buffer_load_dwordx4 v50, s[68:71], s93 offen lds
    s_add_u32 s93, s93, 3584
    s_waitcnt vmcnt(14) lgkmcnt(0)
    buffer_load_dwordx2 v[30:31], v252, s[56:59], s33 offen sc1
    v_mfma_f32_32x32x16_bf16 v[64:79], v[128:131], v[40:43], v[64:79]
    ds_read_b64_tr_b16 v[32:33], v242 offset:0
    ds_read_b64_tr_b16 v[34:35], v242 offset:1024
    ds_read_b64_tr_b16 v[36:37], v243 offset:0
    ds_read_b64_tr_b16 v[38:39], v243 offset:1024
    buffer_load_dwordx4 v[160:163], v60, s[56:59], s94 offen offset:2048 sc1
    v_mfma_f32_32x32x16_bf16 v[80:95], v[128:131], v[44:47], v[80:95]
    buffer_load_dwordx4 v[164:167], v61, s[56:59], s94 offen offset:2048 sc1
    s_add_u32 s94, s94, 4096
    s_cmp_eq_u32 s94, s35
    s_cselect_b32 s94, s34, s94
    s_add_u32 m0, s87, 49152
    v_mfma_f32_32x32x16_bf16 v[96:111], v[132:135], v[40:43], v[96:111]
    buffer_load_dwordx4 v50, s[68:71], s93 offen lds
    s_add_u32 s93, s93, 7168
    s_add_u32 m0, s87, 50176
    v_mfma_f32_32x32x16_bf16 v[112:127], v[132:135], v[44:47], v[112:127]
    buffer_load_dwordx4 v50, s[68:71], s93 offen lds
    s_add_u32 s93, s93, 7168
    s_waitcnt vmcnt(15) lgkmcnt(0)
    v_mfma_f32_32x32x16_bf16 v[64:79], v[136:139], v[32:35], v[64:79]
    ds_read_b64_tr_b16 v[40:41], v242 offset:8192
    ds_read_b64_tr_b16 v[42:43], v242 offset:9216
    ds_read_b64_tr_b16 v[44:45], v243 offset:8192
    ds_read_b64_tr_b16 v[46:47], v243 offset:9216
    v_mfma_f32_32x32x16_bf16 v[80:95], v[136:139], v[36:39], v[80:95]
    s_add_u32 m0, s87, 57344
    v_mfma_f32_32x32x16_bf16 v[96:111], v[140:143], v[32:35], v[96:111]
    buffer_load_dwordx4 v50, s[68:71], s93 offen lds
    s_add_u32 s93, s93, 7168
    s_add_u32 m0, s87, 58368
    v_mfma_f32_32x32x16_bf16 v[112:127], v[140:143], v[36:39], v[112:127]
    buffer_load_dwordx4 v50, s[68:71], s93 offen lds
    s_add_u32 s93, s93, 3584
    s_waitcnt vmcnt(13) lgkmcnt(0)
    v_mfma_f32_32x32x16_bf16 v[64:79], v[144:147], v[40:43], v[64:79]
    ds_read_b64_tr_b16 v[32:33], v242 offset:16384
    ds_read_b64_tr_b16 v[34:35], v242 offset:17408
    ds_read_b64_tr_b16 v[36:37], v243 offset:16384
    ds_read_b64_tr_b16 v[38:39], v243 offset:17408
    v_mfma_f32_32x32x16_bf16 v[80:95], v[144:147], v[44:47], v[80:95]
    v_mfma_f32_32x32x16_bf16 v[96:111], v[148:151], v[40:43], v[96:111]
    v_mfma_f32_32x32x16_bf16 v[112:127], v[148:151], v[44:47], v[112:127]
    s_waitcnt vmcnt(6)
    s_setprio 3
    v_cmp_ne_u64 vcc, s[42:43], v[30:31]
    s_setprio 0
    s_cbranch_vccz ordy_95
    s_waitcnt lgkmcnt(0)
    v_mfma_f32_32x32x16_bf16 v[64:79], v[152:155], v[32:35], v[64:79]
    ds_read_b64_tr_b16 v[40:41], v242 offset:24576
    ds_read_b64_tr_b16 v[42:43], v242 offset:25600
    ds_read_b64_tr_b16 v[44:45], v243 offset:24576
    ds_read_b64_tr_b16 v[46:47], v243 offset:25600
    v_mfma_f32_32x32x16_bf16 v[80:95], v[152:155], v[36:39], v[80:95]
    v_mfma_f32_32x32x16_bf16 v[96:111], v[156:159], v[32:35], v[96:111]
    v_mfma_f32_32x32x16_bf16 v[112:127], v[156:159], v[36:39], v[112:127]
    s_waitcnt vmcnt(4) lgkmcnt(0)
    v_mfma_f32_32x32x16_bf16 v[64:79], v[160:163], v[40:43], v[64:79]
    ds_read_b64_tr_b16 v[8:9], v56 offset:0
    ds_read_b64_tr_b16 v[10:11], v56 offset:1024
    ds_read_b64_tr_b16 v[12:13], v57 offset:0
    ds_read_b64_tr_b16 v[14:15], v57 offset:1024
    ds_read_b64_tr_b16 v[16:17], v56 offset:8192
    ds_read_b64_tr_b16 v[18:19], v56 offset:9216
    ds_read_b64_tr_b16 v[20:21], v57 offset:8192
    ds_read_b64_tr_b16 v[22:23], v57 offset:9216
    v_mfma_f32_32x32x16_bf16 v[80:95], v[160:163], v[44:47], v[80:95]
    v_mfma_f32_32x32x16_bf16 v[96:111], v[164:167], v[40:43], v[96:111]
    v_mfma_f32_32x32x16_bf16 v[112:127], v[164:167], v[44:47], v[112:127]
    s_setprio 3
    v_min_u32 v28, 7, v1
    v_lshlrev_b32 v28, 6, v28
    s_mov_b32 s83, 20000
poll_97:
    buffer_load_dwordx2 v[30:31], v28, s[56:59], s33 offen sc1
    s_waitcnt vmcnt(0)
    v_cmp_ne_u64 vcc, s[42:43], v[30:31]
    s_cbranch_vccz polld_98
    s_sub_u32 s83, s83, 1
    s_cmp_lg_u32 s83, 0
    s_cbranch_scc1 poll_97
polld_98:
    s_setprio 0
    s_setprio 3
    buffer_load_dwordx4 v[168:171], v58, s[56:59], s95 offen offset:0 sc1
    buffer_load_dwordx4 v[172:175], v59, s[56:59], s95 offen offset:0 sc1
    buffer_load_dwordx4 v[176:179], v58, s[56:59], s95 offen offset:2048 sc1
    buffer_load_dwordx4 v[180:183], v59, s[56:59], s95 offen offset:2048 sc1
    s_add_u32 s95, s95, 4096
    buffer_load_dwordx4 v[184:187], v58, s[56:59], s95 offen offset:0 sc1
    buffer_load_dwordx4 v[188:191], v59, s[56:59], s95 offen offset:0 sc1
    buffer_load_dwordx4 v[192:195], v58, s[56:59], s95 offen offset:2048 sc1
    buffer_load_dwordx4 v[196:199], v59, s[56:59], s95 offen offset:2048 sc1
    s_add_u32 s95, s95, 4096
    buffer_load_dwordx4 v[200:203], v58, s[56:59], s95 offen offset:0 sc1
    buffer_load_dwordx4 v[204:207], v59, s[56:59], s95 offen offset:0 sc1
    buffer_load_dwordx4 v[208:211], v58, s[56:59], s95 offen offset:2048 sc1
    buffer_load_dwordx4 v[212:215], v59, s[56:59], s95 offen offset:2048 sc1
    s_add_u32 s95, s95, 4096
    buffer_load_dwordx4 v[216:219], v58, s[56:59], s95 offen offset:0 sc1
    buffer_load_dwordx4 v[220:223], v59, s[56:59], s95 offen offset:0 sc1
    buffer_load_dwordx4 v[224:227], v58, s[56:59], s95 offen offset:2048 sc1
    buffer_load_dwordx4 v[228:231], v59, s[56:59], s95 offen offset:2048 sc1
    s_add_u32 s95, s95, 4096
    s_branch red2_96
ordy_95:
    s_waitcnt lgkmcnt(0)
    v_mfma_f32_32x32x16_bf16 v[64:79], v[152:155], v[32:35], v[64:79]
    ds_read_b64_tr_b16 v[40:41], v242 offset:24576
    ds_read_b64_tr_b16 v[42:43], v242 offset:25600
    ds_read_b64_tr_b16 v[44:45], v243 offset:24576
    ds_read_b64_tr_b16 v[46:47], v243 offset:25600
    buffer_load_dwordx4 v[168:171], v58, s[56:59], s95 offen offset:0 sc1
    v_mfma_f32_32x32x16_bf16 v[80:95], v[152:155], v[36:39], v[80:95]
    buffer_load_dwordx4 v[172:175], v59, s[56:59], s95 offen offset:0 sc1
    v_mfma_f32_32x32x16_bf16 v[96:111], v[156:159], v[32:35], v[96:111]
    v_mfma_f32_32x32x16_bf16 v[112:127], v[156:159], v[36:39], v[112:127]
    buffer_load_dwordx4 v[176:179], v58, s[56:59], s95 offen offset:2048 sc1
    buffer_load_dwordx4 v[180:183], v59, s[56:59], s95 offen offset:2048 sc1
    s_add_u32 s95, s95, 4096
    s_waitcnt vmcnt(8) lgkmcnt(0)
    v_mfma_f32_32x32x16_bf16 v[64:79], v[160:163], v[40:43], v[64:79]
    ds_read_b64_tr_b16 v[8:9], v56 offset:0
    ds_read_b64_tr_b16 v[10:11], v56 offset:1024
    ds_read_b64_tr_b16 v[12:13], v57 offset:0
    ds_read_b64_tr_b16 v[14:15], v57 offset:1024
    ds_read_b64_tr_b16 v[16:17], v56 offset:8192
    ds_read_b64_tr_b16 v[18:19], v56 offset:9216
    ds_read_b64_tr_b16 v[20:21], v57 offset:8192
    ds_read_b64_tr_b16 v[22:23], v57 offset:9216
    buffer_load_dwordx4 v[184:187], v58, s[56:59], s95 offen offset:0 sc1
    v_mfma_f32_32x32x16_bf16 v[80:95], v[160:163], v[44:47], v[80:95]
    buffer_load_dwordx4 v[188:191], v59, s[56:59], s95 offen offset:0 sc1
    v_mfma_f32_32x32x16_bf16 v[96:111], v[164:167], v[40:43], v[96:111]
    v_mfma_f32_32x32x16_bf16 v[112:127], v[164:167], v[44:47], v[112:127]
    buffer_load_dwordx4 v[192:195], v58, s[56:59], s95 offen offset:2048 sc1
    buffer_load_dwordx4 v[196:199], v59, s[56:59], s95 offen offset:2048 sc1
    s_add_u32 s95, s95, 4096
    buffer_load_dwordx4 v[200:203], v58, s[56:59], s95 offen offset:0 sc1
    buffer_load_dwordx4 v[204:207], v59, s[56:59], s95 offen offset:0 sc1
    buffer_load_dwordx4 v[208:211], v58, s[56:59], s95 offen offset:2048 sc1
    buffer_load_dwordx4 v[212:215], v59, s[56:59], s95 offen offset:2048 sc1
    s_add_u32 s95, s95, 4096
    buffer_load_dwordx4 v[216:219], v58, s[56:59], s95 offen offset:0 sc1
    buffer_load_dwordx4 v[220:223], v59, s[56:59], s95 offen offset:0 sc1
    buffer_load_dwordx4 v[224:227], v58, s[56:59], s95 offen offset:2048 sc1
    buffer_load_dwordx4 v[228:231], v59, s[56:59], s95 offen offset:2048 sc1
    s_add_u32 s95, s95, 4096
    s_waitcnt vmcnt(16)
red2_96:
    s_setprio 3
    s_xor_b32 s8, s84, 0
    s_mul_i32 s9, s8, 2048
    s_add_u32 s9, s9, 49152
    v_add_u32 v24, s9, v4
    s_xor_b32 s8, s84, 1
    s_mul_i32 s9, s8, 2048
    s_add_u32 s9, s9, 49152
    v_add_u32 v25, s9, v4
    s_xor_b32 s8, s84, 2
    s_mul_i32 s9, s8, 2048
    s_add_u32 s9, s9, 49152
    v_add_u32 v26, s9, v4
    s_xor_b32 s8, s84, 3
    s_mul_i32 s9, s8, 2048
    s_add_u32 s9, s9, 49152
    v_add_u32 v27, s9, v4
    s_waitcnt vmcnt(14) lgkmcnt(0)
    v_mfma_f32_32x32x16_bf16 v[80:95], v[8:11], v[172:175], v[80:95]
    v_mfma_f32_32x32x16_bf16 v[96:111], v[12:15], v[168:171], v[96:111]
    ds_read_b64_tr_b16 v[128:129], v56 offset:16384
    ds_read_b64_tr_b16 v[130:131], v56 offset:17408
    ds_read_b64_tr_b16 v[132:133], v57 offset:16384
    ds_read_b64_tr_b16 v[134:135], v57 offset:17408
    s_waitcnt vmcnt(12)
    v_mfma_f32_32x32x16_bf16 v[80:95], v[16:19], v[180:183], v[80:95]
    v_mfma_f32_32x32x16_bf16 v[96:111], v[20:23], v[176:179], v[96:111]
    ds_read_b64_tr_b16 v[136:137], v56 offset:24576
    ds_read_b64_tr_b16 v[138:139], v56 offset:25600
    ds_read_b64_tr_b16 v[140:141], v57 offset:24576
    ds_read_b64_tr_b16 v[142:143], v57 offset:25600
    s_waitcnt vmcnt(10) lgkmcnt(4)
    v_mfma_f32_32x32x16_bf16 v[80:95], v[128:131], v[188:191], v[80:95]
    v_mfma_f32_32x32x16_bf16 v[96:111], v[132:135], v[184:187], v[96:111]
    ds_read_b64_tr_b16 v[144:145], v56 offset:32768
    ds_read_b64_tr_b16 v[146:147], v56 offset:33792
    ds_read_b64_tr_b16 v[148:149], v57 offset:32768
    ds_read_b64_tr_b16 v[150:151], v57 offset:33792
    s_waitcnt vmcnt(8) lgkmcnt(4)
    v_mfma_f32_32x32x16_bf16 v[80:95], v[136:139], v[196:199], v[80:95]
    v_mfma_f32_32x32x16_bf16 v[96:111], v[140:143], v[192:195], v[96:111]
    ds_read_b64_tr_b16 v[152:153], v56 offset:40960
    ds_read_b64_tr_b16 v[154:155], v56 offset:41984
    ds_read_b64_tr_b16 v[156:157], v57 offset:40960
    ds_read_b64_tr_b16 v[158:159], v57 offset:41984
    s_waitcnt vmcnt(6) lgkmcnt(4)
    v_mfma_f32_32x32x16_bf16 v[80:95], v[144:147], v[204:207], v[80:95]
    v_mfma_f32_32x32x16_bf16 v[96:111], v[148:151], v[200:203], v[96:111]
    ds_read_b64_tr_b16 v[32:33], v56 offset:49152
    ds_read_b64_tr_b16 v[34:35], v56 offset:50176
    ds_read_b64_tr_b16 v[36:37], v57 offset:49152
    ds_read_b64_tr_b16 v[38:39], v57 offset:50176
    s_waitcnt vmcnt(4) lgkmcnt(4)
    v_mfma_f32_32x32x16_bf16 v[80:95], v[152:155], v[212:215], v[80:95]
    v_mfma_f32_32x32x16_bf16 v[96:111], v[156:159], v[208:211], v[96:111]
    ds_read_b64_tr_b16 v[40:41], v56 offset:57344
    ds_read_b64_tr_b16 v[42:43], v56 offset:58368
    ds_read_b64_tr_b16 v[44:45], v57 offset:57344
    ds_read_b64_tr_b16 v[46:47], v57 offset:58368
    s_waitcnt vmcnt(2) lgkmcnt(4)
    v_mfma_f32_32x32x16_bf16 v[80:95], v[32:35], v[220:223], v[80:95]
    v_mfma_f32_32x32x16_bf16 v[96:111], v[36:39], v[216:219], v[96:111]
    s_waitcnt vmcnt(0) lgkmcnt(0)
    v_mfma_f32_32x32x16_bf16 v[80:95], v[40:43], v[228:231], v[80:95]
    v_mfma_f32_32x32x16_bf16 v[96:111], v[44:47], v[224:227], v[96:111]
    v_mfma_f32_32x32x16_bf16 v[112:127], v[12:15], v[172:175], v[112:127]
    v_mfma_f32_32x32x16_bf16 v[112:127], v[20:23], v[180:183], v[112:127]
    s_nop 8
    ds_write_b128 v24, v[80:83] offset:0
    v_mfma_f32_32x32x16_bf16 v[112:127], v[132:135], v[188:191], v[112:127]
    ds_write_b128 v24, v[84:87] offset:1024
    v_mfma_f32_32x32x16_bf16 v[112:127], v[140:143], v[196:199], v[112:127]
    ds_write_b128 v24, v[88:91] offset:8192
    v_mfma_f32_32x32x16_bf16 v[112:127], v[148:151], v[204:207], v[112:127]
    ds_write_b128 v24, v[92:95] offset:9216
    v_mfma_f32_32x32x16_bf16 v[112:127], v[156:159], v[212:215], v[112:127]
    ds_write_b128 v24, v[96:99] offset:16384
    v_mfma_f32_32x32x16_bf16 v[112:127], v[36:39], v[220:223], v[112:127]
    ds_write_b128 v24, v[100:103] offset:17408
    v_mfma_f32_32x32x16_bf16 v[112:127], v[44:47], v[228:231], v[112:127]
    ds_write_b128 v24, v[104:107] offset:24576
    v_mfma_f32_32x32x16_bf16 v[64:79], v[8:11], v[168:171], v[64:79]
    ds_write_b128 v24, v[108:111] offset:25600
    v_mfma_f32_32x32x16_bf16 v[64:79], v[16:19], v[176:179], v[64:79]
    s_nop 8
    ds_write_b128 v24, v[112:115] offset:32768
    v_mfma_f32_32x32x16_bf16 v[64:79], v[128:131], v[184:187], v[64:79]
    ds_write_b128 v24, v[116:119] offset:33792
    v_mfma_f32_32x32x16_bf16 v[64:79], v[136:139], v[192:195], v[64:79]
    ds_write_b128 v24, v[120:123] offset:40960
    v_mfma_f32_32x32x16_bf16 v[64:79], v[144:147], v[200:203], v[64:79]
    ds_write_b128 v24, v[124:127] offset:41984
    s_mov_b64 exec, 1
    ds_add_u32 v0, v29 offset:36
    s_mov_b64 exec, -1
    v_mfma_f32_32x32x16_bf16 v[64:79], v[152:155], v[208:211], v[64:79]
    v_mfma_f32_32x32x16_bf16 v[64:79], v[32:35], v[216:219], v[64:79]
    v_mfma_f32_32x32x16_bf16 v[64:79], v[40:43], v[224:227], v[64:79]
    s_setprio 3
    s_branch spe_100
spin_99:
    s_sleep 1
spe_100:
    ds_read_b32 v28, v0 offset:36
    s_waitcnt lgkmcnt(0)
    v_readfirstlane_b32 s13, v28
    s_cmp_lt_u32 s13, 4
    s_cbranch_scc1 spin_99
    ds_read_b128 v[80:83], v25 offset:0
    ds_read_b128 v[84:87], v25 offset:1024
    ds_read_b128 v[88:91], v25 offset:8192
    ds_read_b128 v[92:95], v25 offset:9216
    ds_read_b128 v[96:99], v26 offset:16384
    ds_read_b128 v[100:103], v26 offset:17408
    ds_read_b128 v[104:107], v26 offset:24576
    ds_read_b128 v[108:111], v26 offset:25600
    ds_read_b128 v[112:115], v27 offset:32768
    ds_read_b128 v[116:119], v27 offset:33792
    ds_read_b128 v[120:123], v27 offset:40960
    ds_read_b128 v[124:127], v27 offset:41984
    s_waitcnt lgkmcnt(8)
    v_pk_add_f32 v[64:65], v[64:65], v[80:81]
    v_pk_add_f32 v[66:67], v[66:67], v[82:83]
    v_pk_add_f32 v[68:69], v[68:69], v[84:85]
    v_pk_add_f32 v[70:71], v[70:71], v[86:87]
    v_pk_add_f32 v[72:73], v[72:73], v[88:89]
    v_pk_add_f32 v[74:75], v[74:75], v[90:91]
    v_pk_add_f32 v[76:77], v[76:77], v[92:93]
    v_pk_add_f32 v[78:79], v[78:79], v[94:95]
    s_waitcnt lgkmcnt(4)
    v_pk_add_f32 v[64:65], v[64:65], v[96:97]
    v_pk_add_f32 v[66:67], v[66:67], v[98:99]
    v_pk_add_f32 v[68:69], v[68:69], v[100:101]
    v_pk_add_f32 v[70:71], v[70:71], v[102:103]
    v_pk_add_f32 v[72:73], v[72:73], v[104:105]
    v_pk_add_f32 v[74:75], v[74:75], v[106:107]
    v_pk_add_f32 v[76:77], v[76:77], v[108:109]
    v_pk_add_f32 v[78:79], v[78:79], v[110:111]
    s_waitcnt lgkmcnt(0)
    v_pk_add_f32 v[64:65], v[64:65], v[112:113]
    v_pk_add_f32 v[66:67], v[66:67], v[114:115]
    v_pk_add_f32 v[68:69], v[68:69], v[116:117]
    v_pk_add_f32 v[70:71], v[70:71], v[118:119]
    v_pk_add_f32 v[72:73], v[72:73], v[120:121]
    v_pk_add_f32 v[74:75], v[74:75], v[122:123]
    v_pk_add_f32 v[76:77], v[76:77], v[124:125]
    v_pk_add_f32 v[78:79], v[78:79], v[126:127]
    v_cvt_pk_bf16_f32 v80, v64, v65
    v_cvt_pk_bf16_f32 v81, v66, v67
    v_cvt_pk_bf16_f32 v82, v68, v69
    v_cvt_pk_bf16_f32 v83, v70, v71
    v_cvt_pk_bf16_f32 v84, v72, v73
    v_cvt_pk_bf16_f32 v85, v74, v75
    v_cvt_pk_bf16_f32 v86, v76, v77
    v_cvt_pk_bf16_f32 v87, v78, v79
    s_nop 1
    v_permlane32_swap_b32 v80, v82
    v_permlane32_swap_b32 v81, v83
    v_permlane32_swap_b32 v84, v86
    v_permlane32_swap_b32 v85, v87
    buffer_store_dwordx4 v[80:83], v51, s[72:75], s96 offen
    buffer_store_dwordx4 v[84:87], v51, s[72:75], s96 offen offset:32
    s_branch fin
epw:
    s_lshl_b32 s8, s84, 8
    s_add_u32 s8, s8, s2
    s_cmp_lg_u32 s8, 56
    s_cbranch_scc1 fin
    s_branch spe_102
spin_101:
    s_sleep 8
spe_102:
    ds_read_b32 v28, v0 offset:32
    s_waitcnt lgkmcnt(0)
    v_readfirstlane_b32 s13, v28
    s_cmp_lt_u32 s13, 4
    s_cbranch_scc1 spin_101
    s_mov_b32 s8, 10813440
    s_setprio 3
    v_min_u32 v28, 63, v1
    v_lshlrev_b32 v28, 8, v28
    s_mov_b32 s83, 20000
poll_103:
    buffer_load_dwordx2 v[30:31], v28, s[56:59], s8 offen sc1
    s_waitcnt vmcnt(0)
    v_cmp_ne_u64 vcc, s[42:43], v[30:31]
    s_cbranch_vccz polld_104
    s_sub_u32 s83, s83, 1
    s_cmp_lg_u32 s83, 0
    s_cbranch_scc1 poll_103
polld_104:
    s_setprio 0
    s_mov_b32 s8, 10829824
    s_setprio 3
    v_min_u32 v28, 63, v1
    v_lshlrev_b32 v28, 8, v28
    s_mov_b32 s83, 20000
poll_105:
    buffer_load_dwordx2 v[30:31], v28, s[56:59], s8 offen sc1
    s_waitcnt vmcnt(0)
    v_cmp_ne_u64 vcc, s[42:43], v[30:31]
    s_cbranch_vccz polld_106
    s_sub_u32 s83, s83, 1
    s_cmp_lg_u32 s83, 0
    s_cbranch_scc1 poll_105
polld_106:
    s_setprio 0
    s_mov_b32 s8, 10846208
    s_setprio 3
    v_min_u32 v28, 63, v1
    v_lshlrev_b32 v28, 8, v28
    s_mov_b32 s83, 20000
poll_107:
    buffer_load_dwordx2 v[30:31], v28, s[56:59], s8 offen sc1
    s_waitcnt vmcnt(0)
    v_cmp_ne_u64 vcc, s[42:43], v[30:31]
    s_cbranch_vccz polld_108
    s_sub_u32 s83, s83, 1
    s_cmp_lg_u32 s83, 0
    s_cbranch_scc1 poll_107
polld_108:
    s_setprio 0
    s_mov_b32 s8, 10862592
    s_setprio 3
    v_min_u32 v28, 63, v1
    v_lshlrev_b32 v28, 8, v28
    s_mov_b32 s83, 20000
poll_109:
    buffer_load_dwordx2 v[30:31], v28, s[56:59], s8 offen sc1
    s_waitcnt vmcnt(0)
    v_cmp_ne_u64 vcc, s[42:43], v[30:31]
    s_cbranch_vccz polld_110
    s_sub_u32 s83, s83, 1
    s_cmp_lg_u32 s83, 0
    s_cbranch_scc1 poll_109
polld_110:
    s_setprio 0
    s_mov_b32 s8, 11010048
    v_mov_b32 v30, s42
    v_mov_b32 v31, s43
    s_waitcnt vmcnt(0)
    s_mov_b64 exec, 1
    buffer_store_dwordx2 v[30:31], off, s[56:59], s8 sc1
    s_mov_b64 exec, -1
fin:
finx:
    s_endpgm
code_end:
.section .rodata,"a"
.p2align 6
.amdhsa_kernel parallel_sum__grouped_kv_mqa__mixer_token_mlp__prompt_kernel
  .amdhsa_next_free_vgpr 256
  .amdhsa_next_free_sgpr 102
  .amdhsa_accum_offset 256
  .amdhsa_group_segment_fixed_size 0
  .amdhsa_kernarg_size 104
  .amdhsa_user_sgpr_count 2
  .amdhsa_user_sgpr_kernarg_segment_ptr 1
  .amdhsa_system_sgpr_workgroup_id_x 1
  .amdhsa_float_denorm_mode_32 3
.end_amdhsa_kernel
```
